```python
import torch

def _softmax(x, axis=-1):
    return torch.softmax(x, dim=axis)
def _gelu(x):
    return torch.nn.functional.gelu(x, approximate="tanh")
def _silu(x):
    return torch.nn.functional.silu(x)
def _sigmoid(x):
    return torch.sigmoid(x)
def _layernorm(x, axis=-1, eps=1e-5):
    m = x.mean(dim=axis, keepdim=True)
    v = x.var(dim=axis, keepdim=True, unbiased=False)
    return (x - m) / torch.sqrt(v + eps)
def _scatter_add(tgt, idx, src, axis=0):
    return tgt.clone().index_add_(axis, idx, src)
def _segment_sum(src, seg, n):
    out = torch.zeros((n,) + src.shape[1:], dtype=src.dtype)
    return out.index_add_(0, seg, src)
def _pad(x, pw):
    flat = tuple(v for pair in reversed(pw) for v in pair)
    return torch.nn.functional.pad(x, flat)

kernel_name = 'standalone__cross_network_dcn__recsys'

def setup_inputs():

    _w = (lambda a: (lambda t: t.to(torch.bfloat16) if t.is_floating_point() else t)(torch.as_tensor(a)))
    B, F, D, L = 16384, 26, 16, 6
    Din = min(F * D, 1024)
    return {
        "x0": _w((lambda *s: torch.randn(*s, dtype=torch.bfloat16) * 0.05)(B, Din)),
        "ws": _w((lambda *s: torch.randn(*s, dtype=torch.bfloat16) * 0.8)(L, Din, Din) * (Din ** -0.5)),
        "bs": _w((lambda *s: torch.randn(*s, dtype=torch.bfloat16) * 3.2)(L, Din) * 0.01),
    }

def reference(x0, ws, bs):
    x = x0
    L = ws.shape[0]
    for l in range(L):
        proj = torch.einsum('bd,de->be', x, ws[l]) + bs[l]
        x = x0 * proj + x
    return x
```

```asm
; @launch kernel=dcn_prep_kernel grid=(507,1,1) block=(256,1,1) lds=0
; @launch kernel=standalone__cross_network_dcn__recsys_kernel grid=(256,1,1) block=(256,1,1) lds=120832
.amdgcn_target "amdgcn-amd-amdhsa--gfx950"
.text
.globl dcn_prep_kernel
.p2align 8
.type dcn_prep_kernel,@function
dcn_prep_kernel:
  s_cmp_ge_u32 s2, 507
  s_cbranch_scc1 L_prep_end
  s_load_dwordx4 s[4:7], s[0:1], 0
  s_load_dwordx2 s[8:9], s[0:1], 40
  v_lshrrev_b32 v1, 6, v0
  v_and_b32 v2, 63, v0
  v_and_b32 v3, 15, v0
  v_readfirstlane_b32 s3, v1
  v_lshrrev_b32 v4, 4, v2
  s_mul_i32 s10, s2, 4
  s_add_u32 s10, s10, s3
  s_mul_i32 s11, s10, 3103
  s_lshr_b32 s11, s11, 20
  s_mul_i32 s12, s11, 338
  s_sub_u32 s12, s10, s12
  s_mul_i32 s13, s12, 79
  s_lshr_b32 s13, s13, 10
  s_mul_i32 s14, s13, 13
  s_sub_u32 s14, s12, s14
  s_mul_i32 s17, s11, 346112
  s_mul_i32 s18, s14, 26624
  s_add_u32 s17, s17, s18
  s_lshl_b32 s18, s13, 5
  s_add_u32 s17, s17, s18
  v_mul_u32_u24 v5, 6656, v4
  v_lshl_add_u32 v5, v3, 1, v5
  v_add_u32 v6, 3328, v5
  v_lshlrev_b32 v7, 4, v2
  s_lshl_b32 s19, s10, 10
  s_waitcnt lgkmcnt(0)
  s_mov_b32 s20, s6
  s_mov_b32 s21, s7
  s_mov_b32 s22, 2076672
  s_mov_b32 s23, 0x00020000
  s_mov_b32 s24, s8
  s_mov_b32 s25, s9
  s_mov_b32 s26, 2076672
  s_mov_b32 s27, 0x00020000
  buffer_load_ushort v16, v5, s[20:23], s17 offen
  buffer_load_ushort v17, v5, s[20:23], s17 offen offset:832
  buffer_load_ushort v18, v5, s[20:23], s17 offen offset:1664
  buffer_load_ushort v19, v5, s[20:23], s17 offen offset:2496
  buffer_load_ushort v20, v6, s[20:23], s17 offen
  buffer_load_ushort v21, v6, s[20:23], s17 offen offset:832
  buffer_load_ushort v22, v6, s[20:23], s17 offen offset:1664
  buffer_load_ushort v23, v6, s[20:23], s17 offen offset:2496
  s_waitcnt vmcnt(0)
  v_lshl_or_b32 v8, v17, 16, v16
  v_lshl_or_b32 v9, v19, 16, v18
  v_lshl_or_b32 v10, v21, 16, v20
  v_lshl_or_b32 v11, v23, 16, v22
  buffer_store_dwordx4 v[8:11], v7, s[24:27], s19 offen
L_prep_end:
  s_endpgm
.globl standalone__cross_network_dcn__recsys_kernel
.p2align 8
.type standalone__cross_network_dcn__recsys_kernel,@function
standalone__cross_network_dcn__recsys_kernel:
  s_cmp_ge_u32 s2, 256
  s_cbranch_scc1 L_main_end
  s_load_dwordx8 s[4:11], s[0:1], 0
  s_load_dwordx2 s[14:15], s[0:1], 40
  v_lshrrev_b32 v26, 6, v0
  v_and_b32 v27, 63, v0
  v_and_b32 v28, 15, v0
  v_readfirstlane_b32 s3, v26
  v_lshrrev_b32 v29, 4, v27
  v_lshlrev_b32 v1, 4, v27
  s_mul_i32 s49, s3, 13312
  v_add_u32 v13, s49, v1
  v_lshlrev_b32 v23, 2, v0
  v_add_u32 v25, 4096, v23
  s_mov_b32 s51, 3328
  s_mov_b32 s52, 6656
  s_mov_b32 s53, 9984
  s_mul_i32 s33, s2, 53248
  s_waitcnt lgkmcnt(0)
  s_add_u32 s16, s4, s33
  s_addc_u32 s17, s5, 0
  s_mov_b32 s18, 53248
  s_mov_b32 s19, 0x00020000
  s_mov_b32 s28, s8
  s_mov_b32 s29, s9
  s_mov_b32 s30, 4992
  s_mov_b32 s31, 0x00020000
  buffer_load_dword v32, v23, s[28:31], 0 offen
  buffer_load_dword v33, v23, s[28:31], 0 offen offset:1024
  buffer_load_dword v34, v23, s[28:31], 0 offen offset:2048
  buffer_load_dword v35, v23, s[28:31], 0 offen offset:3072
  buffer_load_dword v36, v25, s[28:31], 0 offen
  s_mov_b32 exec_hi, 0x000fffff
  buffer_load_dwordx4 a[0:3], v13, s[16:19], 0 offen
  buffer_load_dwordx4 a[4:7], v13, s[16:19], 0 offen offset:832
  buffer_load_dwordx4 a[8:11], v13, s[16:19], 0 offen offset:1664
  buffer_load_dwordx4 a[12:15], v13, s[16:19], 0 offen offset:2496
  buffer_load_dwordx4 a[16:19], v13, s[16:19], s51 offen
  buffer_load_dwordx4 a[20:23], v13, s[16:19], s51 offen offset:832
  buffer_load_dwordx4 a[24:27], v13, s[16:19], s51 offen offset:1664
  buffer_load_dwordx4 a[28:31], v13, s[16:19], s51 offen offset:2496
  buffer_load_dwordx4 a[32:35], v13, s[16:19], s52 offen
  buffer_load_dwordx4 a[36:39], v13, s[16:19], s52 offen offset:832
  buffer_load_dwordx4 a[40:43], v13, s[16:19], s52 offen offset:1664
  buffer_load_dwordx4 a[44:47], v13, s[16:19], s52 offen offset:2496
  buffer_load_dwordx4 a[48:51], v13, s[16:19], s53 offen
  buffer_load_dwordx4 a[52:55], v13, s[16:19], s53 offen offset:832
  buffer_load_dwordx4 a[56:59], v13, s[16:19], s53 offen offset:1664
  buffer_load_dwordx4 a[60:63], v13, s[16:19], s53 offen offset:2496
  s_mov_b32 exec_hi, -1
  s_add_u32 s20, s10, s33
  s_addc_u32 s21, s11, 0
  s_mov_b32 s22, 53248
  s_mov_b32 s23, 0x00020000
  s_mov_b32 s24, s14
  s_mov_b32 s25, s15
  s_mov_b32 s26, 2076672
  s_mov_b32 s27, 0x00020000
  s_mov_b32 s50, 0xffff0000
  s_mov_b32 s35, 3
  s_mov_b32 s34, 0
  s_lshr_b32 s38, s2, 3
  s_and_b32 s38, s38, 31
  s_mul_i32 s39, s38, 20
  s_lshr_b32 s39, s39, 8
  s_mul_i32 s39, s39, 13
  s_sub_u32 s36, s38, s39
  s_mul_i32 s39, s38, 43
  s_lshr_b32 s39, s39, 8
  s_mul_i32 s39, s39, 6
  s_sub_u32 s37, s38, s39
  s_add_u32 s38, s36, 0
  s_sub_u32 s39, s38, 13
  s_cmp_ge_u32 s38, 13
  s_cselect_b32 s38, s39, s38
  s_lshl_b32 s64, s38, 10
  s_add_u32 s38, s36, 1
  s_sub_u32 s39, s38, 13
  s_cmp_ge_u32 s38, 13
  s_cselect_b32 s38, s39, s38
  s_lshl_b32 s65, s38, 10
  s_add_u32 s38, s36, 2
  s_sub_u32 s39, s38, 13
  s_cmp_ge_u32 s38, 13
  s_cselect_b32 s38, s39, s38
  s_lshl_b32 s66, s38, 10
  s_add_u32 s38, s36, 3
  s_sub_u32 s39, s38, 13
  s_cmp_ge_u32 s38, 13
  s_cselect_b32 s38, s39, s38
  s_lshl_b32 s67, s38, 10
  s_add_u32 s38, s36, 4
  s_sub_u32 s39, s38, 13
  s_cmp_ge_u32 s38, 13
  s_cselect_b32 s38, s39, s38
  s_lshl_b32 s68, s38, 10
  s_add_u32 s38, s36, 5
  s_sub_u32 s39, s38, 13
  s_cmp_ge_u32 s38, 13
  s_cselect_b32 s38, s39, s38
  s_lshl_b32 s69, s38, 10
  s_add_u32 s38, s36, 6
  s_sub_u32 s39, s38, 13
  s_cmp_ge_u32 s38, 13
  s_cselect_b32 s38, s39, s38
  s_lshl_b32 s70, s38, 10
  s_add_u32 s38, s36, 7
  s_sub_u32 s39, s38, 13
  s_cmp_ge_u32 s38, 13
  s_cselect_b32 s38, s39, s38
  s_lshl_b32 s71, s38, 10
  s_add_u32 s38, s36, 8
  s_sub_u32 s39, s38, 13
  s_cmp_ge_u32 s38, 13
  s_cselect_b32 s38, s39, s38
  s_lshl_b32 s72, s38, 10
  s_add_u32 s38, s36, 9
  s_sub_u32 s39, s38, 13
  s_cmp_ge_u32 s38, 13
  s_cselect_b32 s38, s39, s38
  s_lshl_b32 s73, s38, 10
  s_add_u32 s38, s36, 10
  s_sub_u32 s39, s38, 13
  s_cmp_ge_u32 s38, 13
  s_cselect_b32 s38, s39, s38
  s_lshl_b32 s74, s38, 10
  s_add_u32 s38, s36, 11
  s_sub_u32 s39, s38, 13
  s_cmp_ge_u32 s38, 13
  s_cselect_b32 s38, s39, s38
  s_lshl_b32 s75, s38, 10
  s_add_u32 s38, s36, 12
  s_sub_u32 s39, s38, 13
  s_cmp_ge_u32 s38, 13
  s_cselect_b32 s38, s39, s38
  s_lshl_b32 s76, s38, 10
  s_mul_i32 s40, s3, 6
  s_lshr_b32 s38, s3, 1
  s_add_u32 s38, s38, 24
  s_mul_i32 s77, s38, 13312
  s_lshl_b32 s91, s38, 6
  s_lshr_b32 s39, s38, 1
  s_add_u32 s39, s39, 13
  s_sub_u32 s39, s39, s36
  s_sub_u32 s41, s39, 13
  s_cmp_ge_u32 s39, 13
  s_cselect_b32 s39, s41, s39
  s_lshl_b32 s39, s39, 6
  s_and_b32 s38, s38, 1
  s_lshl_b32 s38, s38, 5
  s_add_u32 s84, s39, s38
  s_add_u32 s38, s37, 0
  s_sub_u32 s39, s38, 6
  s_cmp_ge_u32 s38, 6
  s_cselect_b32 s38, s39, s38
  s_add_u32 s38, s38, s40
  s_mul_i32 s78, s38, 13312
  s_lshl_b32 s92, s38, 6
  s_lshr_b32 s39, s38, 1
  s_add_u32 s39, s39, 13
  s_sub_u32 s39, s39, s36
  s_sub_u32 s41, s39, 13
  s_cmp_ge_u32 s39, 13
  s_cselect_b32 s39, s41, s39
  s_lshl_b32 s39, s39, 6
  s_and_b32 s38, s38, 1
  s_lshl_b32 s38, s38, 5
  s_add_u32 s85, s39, s38
  v_add_u32 v7, s77, v1
  v_add_u32 v31, s78, v1
  buffer_load_dwordx4 a[208:211], v7, s[24:27], s64 offen
  buffer_load_dwordx4 a[212:215], v7, s[24:27], s65 offen
  buffer_load_dwordx4 a[216:219], v7, s[24:27], s66 offen
  buffer_load_dwordx4 a[220:223], v7, s[24:27], s67 offen
  buffer_load_dwordx4 a[224:227], v7, s[24:27], s68 offen
  buffer_load_dwordx4 a[228:231], v7, s[24:27], s69 offen
  s_add_u32 s38, s37, 1
  s_sub_u32 s39, s38, 6
  s_cmp_ge_u32 s38, 6
  s_cselect_b32 s38, s39, s38
  s_add_u32 s38, s38, s40
  s_mul_i32 s79, s38, 13312
  s_lshl_b32 s93, s38, 6
  s_lshr_b32 s39, s38, 1
  s_add_u32 s39, s39, 13
  s_sub_u32 s39, s39, s36
  s_sub_u32 s41, s39, 13
  s_cmp_ge_u32 s39, 13
  s_cselect_b32 s39, s41, s39
  s_lshl_b32 s39, s39, 6
  s_and_b32 s38, s38, 1
  s_lshl_b32 s38, s38, 5
  s_add_u32 s86, s39, s38
  s_add_u32 s38, s37, 2
  s_sub_u32 s39, s38, 6
  s_cmp_ge_u32 s38, 6
  s_cselect_b32 s38, s39, s38
  s_add_u32 s38, s38, s40
  s_mul_i32 s80, s38, 13312
  s_lshl_b32 s94, s38, 6
  s_lshr_b32 s39, s38, 1
  s_add_u32 s39, s39, 13
  s_sub_u32 s39, s39, s36
  s_sub_u32 s41, s39, 13
  s_cmp_ge_u32 s39, 13
  s_cselect_b32 s39, s41, s39
  s_lshl_b32 s39, s39, 6
  s_and_b32 s38, s38, 1
  s_lshl_b32 s38, s38, 5
  s_add_u32 s87, s39, s38
  s_add_u32 s38, s37, 3
  s_sub_u32 s39, s38, 6
  s_cmp_ge_u32 s38, 6
  s_cselect_b32 s38, s39, s38
  s_add_u32 s38, s38, s40
  s_mul_i32 s81, s38, 13312
  s_lshl_b32 s95, s38, 6
  s_lshr_b32 s39, s38, 1
  s_add_u32 s39, s39, 13
  s_sub_u32 s39, s39, s36
  s_sub_u32 s41, s39, 13
  s_cmp_ge_u32 s39, 13
  s_cselect_b32 s39, s41, s39
  s_lshl_b32 s39, s39, 6
  s_and_b32 s38, s38, 1
  s_lshl_b32 s38, s38, 5
  s_add_u32 s88, s39, s38
  s_add_u32 s38, s37, 4
  s_sub_u32 s39, s38, 6
  s_cmp_ge_u32 s38, 6
  s_cselect_b32 s38, s39, s38
  s_add_u32 s38, s38, s40
  s_mul_i32 s82, s38, 13312
  s_lshl_b32 s96, s38, 6
  s_lshr_b32 s39, s38, 1
  s_add_u32 s39, s39, 13
  s_sub_u32 s39, s39, s36
  s_sub_u32 s41, s39, 13
  s_cmp_ge_u32 s39, 13
  s_cselect_b32 s39, s41, s39
  s_lshl_b32 s39, s39, 6
  s_and_b32 s38, s38, 1
  s_lshl_b32 s38, s38, 5
  s_add_u32 s89, s39, s38
  s_add_u32 s38, s37, 5
  s_sub_u32 s39, s38, 6
  s_cmp_ge_u32 s38, 6
  s_cselect_b32 s38, s39, s38
  s_add_u32 s38, s38, s40
  s_mul_i32 s83, s38, 13312
  s_lshl_b32 s97, s38, 6
  s_lshr_b32 s39, s38, 1
  s_add_u32 s39, s39, 13
  s_sub_u32 s39, s39, s36
  s_sub_u32 s41, s39, 13
  s_cmp_ge_u32 s39, 13
  s_cselect_b32 s39, s41, s39
  s_lshl_b32 s39, s39, 6
  s_and_b32 s38, s38, 1
  s_lshl_b32 s38, s38, 5
  s_add_u32 s90, s39, s38
  v_mul_u32_u24 v16, 864, v28
  v_lshl_add_u32 v30, v29, 4, v16
  v_lshl_add_u32 v18, v29, 3, v16
  s_and_b32 s38, s3, 1
  s_mul_i32 s45, s38, 55296
  s_sub_u32 s54, 55296, s45
  v_add_u32 v2, s45, v30
  v_add_u32 v3, s54, v30
  v_add_u32 v4, s45, v18
  v_add_u32 v5, s54, v18
  v_lshlrev_b32 v20, 4, v29
  v_add_u32 v6, 110592, v20
  v_lshrrev_b32 v17, 2, v27
  v_add_u32 v17, 13, v17
  v_subrev_u32 v17, s36, v17
  v_subrev_u32 v19, 13, v17
  v_cmp_le_u32 vcc, 13, v17
  s_nop 1
  v_cndmask_b32 v17, v17, v19, vcc
  v_and_b32 v19, 3, v27
  v_lshlrev_b32 v19, 4, v19
  v_lshl_add_u32 v17, v17, 6, v19
  s_mul_i32 s49, s3, 27648
  v_add_u32 v12, s49, v17
  v_lshlrev_b32 v24, 3, v0
  v_add_u32 v24, 110592, v24
  s_waitcnt vmcnt(22)
  v_lshlrev_b32 v40, 16, v32
  v_and_b32 v41, s50, v32
  ds_write_b64 v24, v[40:41]
  v_lshlrev_b32 v42, 16, v33
  v_and_b32 v43, s50, v33
  ds_write_b64 v24, v[42:43] offset:2048
  v_lshlrev_b32 v44, 16, v34
  v_and_b32 v45, s50, v34
  ds_write_b64 v24, v[44:45] offset:4096
  v_lshlrev_b32 v46, 16, v35
  v_and_b32 v47, s50, v35
  ds_write_b64 v24, v[46:47] offset:6144
  v_lshlrev_b32 v48, 16, v36
  v_and_b32 v49, s50, v36
  ds_write_b64 v24, v[48:49] offset:8192
  s_mov_b32 exec_hi, 0x000fffff
  s_waitcnt vmcnt(20)
  ds_write_b128 v12, a[0:3]
  ds_write_b128 v12, a[4:7] offset:864
  s_waitcnt vmcnt(18)
  ds_write_b128 v12, a[8:11] offset:1728
  ds_write_b128 v12, a[12:15] offset:2592
  s_waitcnt vmcnt(16)
  ds_write_b128 v12, a[16:19] offset:3456
  ds_write_b128 v12, a[20:23] offset:4320
  s_waitcnt vmcnt(14)
  ds_write_b128 v12, a[24:27] offset:5184
  ds_write_b128 v12, a[28:31] offset:6048
  s_waitcnt vmcnt(12)
  ds_write_b128 v12, a[32:35] offset:6912
  ds_write_b128 v12, a[36:39] offset:7776
  s_waitcnt vmcnt(10)
  ds_write_b128 v12, a[40:43] offset:8640
  ds_write_b128 v12, a[44:47] offset:9504
  s_waitcnt vmcnt(8)
  ds_write_b128 v12, a[48:51] offset:10368
  ds_write_b128 v12, a[52:55] offset:11232
  s_waitcnt vmcnt(6)
  ds_write_b128 v12, a[56:59] offset:12096
  ds_write_b128 v12, a[60:63] offset:12960
  s_mov_b32 exec_hi, -1
  s_waitcnt lgkmcnt(0)
  s_barrier
  v_add_u32 v8, s84, v4
  ds_read_b64 v[82:83], v8
  ds_read_b64 v[86:87], v8 offset:27648
  buffer_load_dwordx4 a[232:235], v7, s[24:27], s70 offen
  buffer_load_dwordx4 a[236:239], v7, s[24:27], s71 offen
  buffer_load_dwordx4 a[240:243], v7, s[24:27], s72 offen
  buffer_load_dwordx4 a[244:247], v7, s[24:27], s73 offen
  v_add_u32 v8, s85, v4
  v_add_u32 v9, s85, v5
  ds_read_b64 v[90:91], v8
  ds_read_b64 v[94:95], v8 offset:27648
  ds_read_b64 v[98:99], v9
  ds_read_b64 v[102:103], v9 offset:27648
  buffer_load_dwordx4 a[248:251], v7, s[24:27], s74 offen
  buffer_load_dwordx4 a[252:255], v7, s[24:27], s75 offen
  buffer_load_dwordx4 v[184:187], v7, s[24:27], s76 offen
  buffer_load_dwordx4 v[188:191], v31, s[24:27], s64 offen
  v_add_u32 v8, s86, v4
  v_add_u32 v9, s86, v5
  ds_read_b64 v[106:107], v8
  ds_read_b64 v[110:111], v8 offset:27648
  ds_read_b64 v[114:115], v9
  ds_read_b64 v[118:119], v9 offset:27648
  buffer_load_dwordx4 v[192:195], v31, s[24:27], s65 offen
  buffer_load_dwordx4 v[196:199], v31, s[24:27], s66 offen
  buffer_load_dwordx4 v[200:203], v31, s[24:27], s67 offen
  buffer_load_dwordx4 v[204:207], v31, s[24:27], s68 offen
  v_add_u32 v8, s87, v4
  v_add_u32 v9, s87, v5
  ds_read_b64 v[122:123], v8
  ds_read_b64 v[126:127], v8 offset:27648
  ds_read_b64 v[130:131], v9
  ds_read_b64 v[134:135], v9 offset:27648
  buffer_load_dwordx4 v[208:211], v31, s[24:27], s69 offen
  buffer_load_dwordx4 v[212:215], v31, s[24:27], s70 offen
  buffer_load_dwordx4 v[216:219], v31, s[24:27], s71 offen
  buffer_load_dwordx4 v[220:223], v31, s[24:27], s72 offen
  s_waitcnt lgkmcnt(10)
  v_lshlrev_b32 v80, 16, v82
  v_and_b32 v81, s50, v82
  v_lshlrev_b32 v82, 16, v83
  v_and_b32 v83, s50, v83
  v_lshlrev_b32 v84, 16, v86
  v_and_b32 v85, s50, v86
  v_lshlrev_b32 v86, 16, v87
  v_and_b32 v87, s50, v87
  v_lshlrev_b32 v88, 16, v90
  v_and_b32 v89, s50, v90
  v_lshlrev_b32 v90, 16, v91
  v_and_b32 v91, s50, v91
  v_lshlrev_b32 v92, 16, v94
  v_and_b32 v93, s50, v94
  v_lshlrev_b32 v94, 16, v95
  v_and_b32 v95, s50, v95
  v_add_u32 v8, s88, v4
  v_add_u32 v9, s88, v5
  ds_read_b64 v[138:139], v8
  ds_read_b64 v[142:143], v8 offset:27648
  ds_read_b64 v[146:147], v9
  ds_read_b64 v[150:151], v9 offset:27648
  buffer_load_dwordx4 v[224:227], v31, s[24:27], s73 offen
  buffer_load_dwordx4 v[228:231], v31, s[24:27], s74 offen
  buffer_load_dwordx4 v[232:235], v31, s[24:27], s75 offen
  buffer_load_dwordx4 v[236:239], v31, s[24:27], s76 offen
  s_waitcnt lgkmcnt(10)
  v_lshlrev_b32 v96, 16, v98
  v_and_b32 v97, s50, v98
  v_lshlrev_b32 v98, 16, v99
  v_and_b32 v99, s50, v99
  v_lshlrev_b32 v100, 16, v102
  v_and_b32 v101, s50, v102
  v_lshlrev_b32 v102, 16, v103
  v_and_b32 v103, s50, v103
  v_lshlrev_b32 v104, 16, v106
  v_and_b32 v105, s50, v106
  v_lshlrev_b32 v106, 16, v107
  v_and_b32 v107, s50, v107
  v_lshlrev_b32 v108, 16, v110
  v_and_b32 v109, s50, v110
  v_lshlrev_b32 v110, 16, v111
  v_and_b32 v111, s50, v111
  v_add_u32 v8, s89, v4
  v_add_u32 v9, s89, v5
  ds_read_b64 v[154:155], v8
  ds_read_b64 v[158:159], v8 offset:27648
  ds_read_b64 v[162:163], v9
  ds_read_b64 v[166:167], v9 offset:27648
  s_waitcnt lgkmcnt(10)
  v_lshlrev_b32 v112, 16, v114
  v_and_b32 v113, s50, v114
  v_lshlrev_b32 v114, 16, v115
  v_and_b32 v115, s50, v115
  v_lshlrev_b32 v116, 16, v118
  v_and_b32 v117, s50, v118
  v_lshlrev_b32 v118, 16, v119
  v_and_b32 v119, s50, v119
  v_lshlrev_b32 v120, 16, v122
  v_and_b32 v121, s50, v122
  v_lshlrev_b32 v122, 16, v123
  v_and_b32 v123, s50, v123
  v_lshlrev_b32 v124, 16, v126
  v_and_b32 v125, s50, v126
  v_lshlrev_b32 v126, 16, v127
  v_and_b32 v127, s50, v127
  v_add_u32 v8, s90, v4
  v_add_u32 v9, s90, v5
  ds_read_b64 v[170:171], v8
  ds_read_b64 v[174:175], v8 offset:27648
  ds_read_b64 v[178:179], v9
  ds_read_b64 v[182:183], v9 offset:27648
  s_waitcnt lgkmcnt(10)
  v_lshlrev_b32 v128, 16, v130
  v_and_b32 v129, s50, v130
  v_lshlrev_b32 v130, 16, v131
  v_and_b32 v131, s50, v131
  v_lshlrev_b32 v132, 16, v134
  v_and_b32 v133, s50, v134
  v_lshlrev_b32 v134, 16, v135
  v_and_b32 v135, s50, v135
  v_lshlrev_b32 v136, 16, v138
  v_and_b32 v137, s50, v138
  v_lshlrev_b32 v138, 16, v139
  v_and_b32 v139, s50, v139
  v_lshlrev_b32 v140, 16, v142
  v_and_b32 v141, s50, v142
  v_lshlrev_b32 v142, 16, v143
  v_and_b32 v143, s50, v143
  s_waitcnt lgkmcnt(6)
  v_lshlrev_b32 v144, 16, v146
  v_and_b32 v145, s50, v146
  v_lshlrev_b32 v146, 16, v147
  v_and_b32 v147, s50, v147
  v_lshlrev_b32 v148, 16, v150
  v_and_b32 v149, s50, v150
  v_lshlrev_b32 v150, 16, v151
  v_and_b32 v151, s50, v151
  v_lshlrev_b32 v152, 16, v154
  v_and_b32 v153, s50, v154
  v_lshlrev_b32 v154, 16, v155
  v_and_b32 v155, s50, v155
  v_lshlrev_b32 v156, 16, v158
  v_and_b32 v157, s50, v158
  v_lshlrev_b32 v158, 16, v159
  v_and_b32 v159, s50, v159
  s_waitcnt lgkmcnt(2)
  v_lshlrev_b32 v160, 16, v162
  v_and_b32 v161, s50, v162
  v_lshlrev_b32 v162, 16, v163
  v_and_b32 v163, s50, v163
  v_lshlrev_b32 v164, 16, v166
  v_and_b32 v165, s50, v166
  v_lshlrev_b32 v166, 16, v167
  v_and_b32 v167, s50, v167
  v_lshlrev_b32 v168, 16, v170
  v_and_b32 v169, s50, v170
  v_lshlrev_b32 v170, 16, v171
  v_and_b32 v171, s50, v171
  v_lshlrev_b32 v172, 16, v174
  v_and_b32 v173, s50, v174
  v_lshlrev_b32 v174, 16, v175
  v_and_b32 v175, s50, v175
  s_waitcnt lgkmcnt(0)
  v_lshlrev_b32 v176, 16, v178
  v_and_b32 v177, s50, v178
  v_lshlrev_b32 v178, 16, v179
  v_and_b32 v179, s50, v179
  v_lshlrev_b32 v180, 16, v182
  v_and_b32 v181, s50, v182
  v_lshlrev_b32 v182, 16, v183
  v_and_b32 v183, s50, v183
L_loop:
  v_add_u32 v240, s92, v6
  ds_read_b128 v[52:55], v240 offset:0
  ds_read_b128 a[0:3], v2 offset:0
  ds_read_b128 a[4:7], v2 offset:27648
  ds_read_b128 a[8:11], v3 offset:0
  ds_read_b128 a[12:15], v3 offset:27648
  v_add_u32 v240, s91, v6
  ds_read_b128 v[48:51], v240 offset:0
  ds_read_b128 a[16:19], v2 offset:64
  ds_read_b128 a[20:23], v2 offset:27712
  ds_read_b128 a[24:27], v3 offset:64
  ds_read_b128 a[28:31], v3 offset:27712
  ds_read_b128 a[32:35], v2 offset:128
  ds_read_b128 a[36:39], v2 offset:27776
  s_add_u32 s33, s34, s79
  v_add_u32 v7, s33, v1
  s_add_u32 s33, s34, s80
  v_add_u32 v241, s33, v1
  s_waitcnt vmcnt(11) lgkmcnt(6)
  v_mfma_f32_16x16x32_bf16 v[32:35], v[188:191], a[0:3], v[52:55]
  ds_read_b128 a[40:43], v3 offset:128
  ds_read_b128 a[44:47], v3 offset:27776
  v_mfma_f32_16x16x32_bf16 v[36:39], v[188:191], a[4:7], v[52:55]
  ds_read_b128 a[48:51], v2 offset:192
  ds_read_b128 a[52:55], v2 offset:27840
  v_mfma_f32_16x16x32_bf16 v[244:247], a[208:211], a[0:3], v[48:51]
  ds_read_b128 a[56:59], v3 offset:192
  ds_read_b128 a[60:63], v3 offset:27840
  v_mfma_f32_16x16x32_bf16 v[40:43], v[188:191], a[8:11], v[52:55]
  ds_read_b128 a[64:67], v2 offset:256
  ds_read_b128 a[68:71], v2 offset:27904
  v_mfma_f32_16x16x32_bf16 v[248:251], a[208:211], a[4:7], v[48:51]
  buffer_load_dwordx4 a[208:211], v7, s[24:27], s64 offen
  ds_read_b128 a[72:75], v3 offset:256
  v_mfma_f32_16x16x32_bf16 v[44:47], v[188:191], a[12:15], v[52:55]
  buffer_load_dwordx4 v[188:191], v241, s[24:27], s64 offen
  s_waitcnt lgkmcnt(11)
  v_mfma_f32_16x16x32_bf16 v[32:35], v[192:195], a[16:19], v[32:35]
  ds_read_b128 a[76:79], v3 offset:27904
  ds_read_b128 a[80:83], v2 offset:320
  v_mfma_f32_16x16x32_bf16 v[36:39], v[192:195], a[20:23], v[36:39]
  ds_read_b128 a[84:87], v2 offset:27968
  ds_read_b128 a[88:91], v3 offset:320
  v_mfma_f32_16x16x32_bf16 v[244:247], a[212:215], a[16:19], v[244:247]
  ds_read_b128 a[92:95], v3 offset:27968
  ds_read_b128 a[96:99], v2 offset:384
  v_mfma_f32_16x16x32_bf16 v[40:43], v[192:195], a[24:27], v[40:43]
  ds_read_b128 a[100:103], v2 offset:28032
  ds_read_b128 a[104:107], v3 offset:384
  v_mfma_f32_16x16x32_bf16 v[248:251], a[212:215], a[20:23], v[248:251]
  buffer_load_dwordx4 a[212:215], v7, s[24:27], s65 offen
  ds_read_b128 a[108:111], v3 offset:28032
  v_mfma_f32_16x16x32_bf16 v[44:47], v[192:195], a[28:31], v[44:47]
  buffer_load_dwordx4 v[192:195], v241, s[24:27], s65 offen
  s_waitcnt vmcnt(13) lgkmcnt(15)
  v_mfma_f32_16x16x32_bf16 v[32:35], v[196:199], a[32:35], v[32:35]
  ds_read_b128 a[112:115], v2 offset:448
  ds_read_b128 a[116:119], v2 offset:28096
  v_mfma_f32_16x16x32_bf16 v[36:39], v[196:199], a[36:39], v[36:39]
  ds_read_b128 a[120:123], v3 offset:448
  ds_read_b128 a[124:127], v3 offset:28096
  v_mfma_f32_16x16x32_bf16 v[244:247], a[216:219], a[32:35], v[244:247]
  ds_read_b128 a[128:131], v2 offset:512
  ds_read_b128 a[132:135], v2 offset:28160
  v_mfma_f32_16x16x32_bf16 v[40:43], v[196:199], a[40:43], v[40:43]
  ds_read_b128 a[136:139], v3 offset:512
  ds_read_b128 a[140:143], v3 offset:28160
  v_mfma_f32_16x16x32_bf16 v[248:251], a[216:219], a[36:39], v[248:251]
  buffer_load_dwordx4 a[216:219], v7, s[24:27], s66 offen
  ds_read_b128 a[144:147], v2 offset:576
  v_mfma_f32_16x16x32_bf16 v[44:47], v[196:199], a[44:47], v[44:47]
  buffer_load_dwordx4 v[196:199], v241, s[24:27], s66 offen
  s_waitcnt lgkmcnt(15)
  v_mfma_f32_16x16x32_bf16 v[32:35], v[200:203], a[48:51], v[32:35]
  ds_read_b128 a[148:151], v2 offset:28224
  ds_read_b128 a[152:155], v3 offset:576
  v_mfma_f32_16x16x32_bf16 v[36:39], v[200:203], a[52:55], v[36:39]
  ds_read_b128 a[156:159], v3 offset:28224
  ds_read_b128 a[160:163], v2 offset:640
  v_mfma_f32_16x16x32_bf16 v[244:247], a[220:223], a[48:51], v[244:247]
  ds_read_b128 a[164:167], v2 offset:28288
  ds_read_b128 a[168:171], v3 offset:640
  v_mfma_f32_16x16x32_bf16 v[40:43], v[200:203], a[56:59], v[40:43]
  ds_read_b128 a[172:175], v3 offset:28288
  ds_read_b128 a[176:179], v2 offset:704
  v_mfma_f32_16x16x32_bf16 v[248:251], a[220:223], a[52:55], v[248:251]
  buffer_load_dwordx4 a[220:223], v7, s[24:27], s67 offen
  ds_read_b128 a[180:183], v2 offset:28352
  v_mfma_f32_16x16x32_bf16 v[44:47], v[200:203], a[60:63], v[44:47]
  buffer_load_dwordx4 v[200:203], v241, s[24:27], s67 offen
  s_waitcnt vmcnt(15)
  v_mfma_f32_16x16x32_bf16 v[32:35], v[204:207], a[64:67], v[32:35]
  ds_read_b128 a[184:187], v3 offset:704
  ds_read_b128 a[188:191], v3 offset:28352
  v_mfma_f32_16x16x32_bf16 v[36:39], v[204:207], a[68:71], v[36:39]
  ds_read_b128 a[192:195], v2 offset:768
  ds_read_b128 a[196:199], v2 offset:28416
  v_mfma_f32_16x16x32_bf16 v[244:247], a[224:227], a[64:67], v[244:247]
  ds_read_b128 a[200:203], v3 offset:768
  ds_read_b128 a[204:207], v3 offset:28416
  v_mfma_f32_16x16x32_bf16 v[40:43], v[204:207], a[72:75], v[40:43]
  v_add_u32 v8, s84, v4
  ds_read_b64 v[56:57], v8 offset:0
  v_mfma_f32_16x16x32_bf16 v[248:251], a[224:227], a[68:71], v[248:251]
  buffer_load_dwordx4 a[224:227], v7, s[24:27], s68 offen
  ds_read_b64 v[58:59], v8 offset:27648
  v_mfma_f32_16x16x32_bf16 v[44:47], v[204:207], a[76:79], v[44:47]
  buffer_load_dwordx4 v[204:207], v241, s[24:27], s68 offen
  s_waitcnt lgkmcnt(15)
  v_mfma_f32_16x16x32_bf16 v[32:35], v[208:211], a[80:83], v[32:35]
  v_add_u32 v10, s85, v4
  v_add_u32 v11, s85, v5
  v_mfma_f32_16x16x32_bf16 v[36:39], v[208:211], a[84:87], v[36:39]
  ds_read_b64 v[64:65], v10 offset:0
  ds_read_b64 v[66:67], v10 offset:27648
  v_mfma_f32_16x16x32_bf16 v[244:247], a[228:231], a[80:83], v[244:247]
  ds_read_b64 v[68:69], v11 offset:0
  ds_read_b64 v[70:71], v11 offset:27648
  v_mfma_f32_16x16x32_bf16 v[40:43], v[208:211], a[88:91], v[40:43]
  v_add_u32 v240, s93, v6
  ds_read_b128 v[48:51], v240 offset:0
  v_mfma_f32_16x16x32_bf16 v[248:251], a[228:231], a[84:87], v[248:251]
  buffer_load_dwordx4 a[228:231], v7, s[24:27], s69 offen
  v_mfma_f32_16x16x32_bf16 v[44:47], v[208:211], a[92:95], v[44:47]
  buffer_load_dwordx4 v[208:211], v241, s[24:27], s69 offen
  s_waitcnt vmcnt(17)
  v_mfma_f32_16x16x32_bf16 v[32:35], v[212:215], a[96:99], v[32:35]
  v_mfma_f32_16x16x32_bf16 v[36:39], v[212:215], a[100:103], v[36:39]
  v_mfma_f32_16x16x32_bf16 v[244:247], a[232:235], a[96:99], v[244:247]
  v_mfma_f32_16x16x32_bf16 v[40:43], v[212:215], a[104:107], v[40:43]
  v_mfma_f32_16x16x32_bf16 v[248:251], a[232:235], a[100:103], v[248:251]
  buffer_load_dwordx4 a[232:235], v7, s[24:27], s70 offen
  v_mfma_f32_16x16x32_bf16 v[44:47], v[212:215], a[108:111], v[44:47]
  buffer_load_dwordx4 v[212:215], v241, s[24:27], s70 offen
  v_mfma_f32_16x16x32_bf16 v[32:35], v[216:219], a[112:115], v[32:35]
  v_mfma_f32_16x16x32_bf16 v[36:39], v[216:219], a[116:119], v[36:39]
  v_mfma_f32_16x16x32_bf16 v[244:247], a[236:239], a[112:115], v[244:247]
  v_mfma_f32_16x16x32_bf16 v[40:43], v[216:219], a[120:123], v[40:43]
  v_mfma_f32_16x16x32_bf16 v[248:251], a[236:239], a[116:119], v[248:251]
  buffer_load_dwordx4 a[236:239], v7, s[24:27], s71 offen
  v_mfma_f32_16x16x32_bf16 v[44:47], v[216:219], a[124:127], v[44:47]
  buffer_load_dwordx4 v[216:219], v241, s[24:27], s71 offen
  s_waitcnt vmcnt(19)
  v_mfma_f32_16x16x32_bf16 v[32:35], v[220:223], a[128:131], v[32:35]
  v_mfma_f32_16x16x32_bf16 v[36:39], v[220:223], a[132:135], v[36:39]
  v_mfma_f32_16x16x32_bf16 v[244:247], a[240:243], a[128:131], v[244:247]
  v_mfma_f32_16x16x32_bf16 v[40:43], v[220:223], a[136:139], v[40:43]
  v_mfma_f32_16x16x32_bf16 v[248:251], a[240:243], a[132:135], v[248:251]
  buffer_load_dwordx4 a[240:243], v7, s[24:27], s72 offen
  v_mfma_f32_16x16x32_bf16 v[44:47], v[220:223], a[140:143], v[44:47]
  buffer_load_dwordx4 v[220:223], v241, s[24:27], s72 offen
  s_waitcnt lgkmcnt(15)
  v_mfma_f32_16x16x32_bf16 v[32:35], v[224:227], a[144:147], v[32:35]
  v_mfma_f32_16x16x32_bf16 v[36:39], v[224:227], a[148:151], v[36:39]
  v_mfma_f32_16x16x32_bf16 v[244:247], a[244:247], a[144:147], v[244:247]
  v_mfma_f32_16x16x32_bf16 v[40:43], v[224:227], a[152:155], v[40:43]
  v_mfma_f32_16x16x32_bf16 v[248:251], a[244:247], a[148:151], v[248:251]
  buffer_load_dwordx4 a[244:247], v7, s[24:27], s73 offen
  v_mfma_f32_16x16x32_bf16 v[44:47], v[224:227], a[156:159], v[44:47]
  buffer_load_dwordx4 v[224:227], v241, s[24:27], s73 offen
  s_waitcnt vmcnt(21)
  v_mfma_f32_16x16x32_bf16 v[32:35], v[228:231], a[160:163], v[32:35]
  v_mfma_f32_16x16x32_bf16 v[36:39], v[228:231], a[164:167], v[36:39]
  v_mfma_f32_16x16x32_bf16 v[244:247], a[248:251], a[160:163], v[244:247]
  v_mfma_f32_16x16x32_bf16 v[40:43], v[228:231], a[168:171], v[40:43]
  v_mfma_f32_16x16x32_bf16 v[248:251], a[248:251], a[164:167], v[248:251]
  buffer_load_dwordx4 a[248:251], v7, s[24:27], s74 offen
  v_mfma_f32_16x16x32_bf16 v[44:47], v[228:231], a[172:175], v[44:47]
  buffer_load_dwordx4 v[228:231], v241, s[24:27], s74 offen
  s_waitcnt lgkmcnt(11)
  v_mfma_f32_16x16x32_bf16 v[32:35], v[232:235], a[176:179], v[32:35]
  v_mfma_f32_16x16x32_bf16 v[36:39], v[232:235], a[180:183], v[36:39]
  v_mfma_f32_16x16x32_bf16 v[244:247], a[252:255], a[176:179], v[244:247]
  v_mfma_f32_16x16x32_bf16 v[40:43], v[232:235], a[184:187], v[40:43]
  v_mfma_f32_16x16x32_bf16 v[248:251], a[252:255], a[180:183], v[248:251]
  buffer_load_dwordx4 a[252:255], v7, s[24:27], s75 offen
  v_mfma_f32_16x16x32_bf16 v[44:47], v[232:235], a[188:191], v[44:47]
  buffer_load_dwordx4 v[232:235], v241, s[24:27], s75 offen
  s_waitcnt vmcnt(24) lgkmcnt(7)
  v_mfma_f32_16x16x32_bf16 v[32:35], v[236:239], a[192:195], v[32:35]
  v_mfma_f32_16x16x32_bf16 v[36:39], v[236:239], a[196:199], v[36:39]
  v_mfma_f32_16x16x32_bf16 v[244:247], v[184:187], a[192:195], v[244:247]
  v_mfma_f32_16x16x32_bf16 v[40:43], v[236:239], a[200:203], v[40:43]
  v_mfma_f32_16x16x32_bf16 v[248:251], v[184:187], a[196:199], v[248:251]
  buffer_load_dwordx4 v[184:187], v7, s[24:27], s76 offen
  v_mfma_f32_16x16x32_bf16 v[44:47], v[236:239], a[204:207], v[44:47]
  buffer_load_dwordx4 v[236:239], v241, s[24:27], s76 offen
  s_add_u32 s33, s34, s81
  v_add_u32 v7, s33, v1
  s_waitcnt vmcnt(23) lgkmcnt(0)
  v_mfma_f32_16x16x32_bf16 v[16:19], a[208:211], a[0:3], v[48:51]
  v_mfma_f32_16x16x32_bf16 v[20:23], a[208:211], a[4:7], v[48:51]
  v_mfma_f32_16x16x32_bf16 v[24:27], a[208:211], a[8:11], v[48:51]
  v_mfma_f32_16x16x32_bf16 v[28:31], a[208:211], a[12:15], v[48:51]
  buffer_load_dwordx4 a[208:211], v7, s[24:27], s64 offen
  v_mfma_f32_16x16x32_bf16 v[16:19], a[212:215], a[16:19], v[16:19]
  v_lshlrev_b32 v72, 16, v56
  v_and_b32 v73, s50, v56
  v_mfma_f32_16x16x32_bf16 v[20:23], a[212:215], a[20:23], v[20:23]
  v_lshlrev_b32 v74, 16, v57
  v_and_b32 v75, s50, v57
  v_mfma_f32_16x16x32_bf16 v[24:27], a[212:215], a[24:27], v[24:27]
  v_fma_f32 v244, v80, v244, v72
  v_fma_f32 v245, v81, v245, v73
  v_mfma_f32_16x16x32_bf16 v[28:31], a[212:215], a[28:31], v[28:31]
  buffer_load_dwordx4 a[212:215], v7, s[24:27], s65 offen
  s_waitcnt vmcnt(21)
  v_mfma_f32_16x16x32_bf16 v[16:19], a[216:219], a[32:35], v[16:19]
  v_fma_f32 v246, v82, v246, v74
  v_fma_f32 v247, v83, v247, v75
  v_mfma_f32_16x16x32_bf16 v[20:23], a[216:219], a[36:39], v[20:23]
  v_cvt_pk_bf16_f32 v56, v244, v245
  v_cvt_pk_bf16_f32 v57, v246, v247
  v_mfma_f32_16x16x32_bf16 v[24:27], a[216:219], a[40:43], v[24:27]
  ds_write_b64 v8, v[56:57] offset:13824
  v_lshlrev_b32 v76, 16, v58
  v_mfma_f32_16x16x32_bf16 v[28:31], a[216:219], a[44:47], v[28:31]
  buffer_load_dwordx4 a[216:219], v7, s[24:27], s66 offen
  v_and_b32 v77, s50, v58
  v_mfma_f32_16x16x32_bf16 v[16:19], a[220:223], a[48:51], v[16:19]
  v_lshlrev_b32 v78, 16, v59
  v_and_b32 v79, s50, v59
  v_mfma_f32_16x16x32_bf16 v[20:23], a[220:223], a[52:55], v[20:23]
  v_fma_f32 v248, v84, v248, v76
  v_fma_f32 v249, v85, v249, v77
  v_mfma_f32_16x16x32_bf16 v[24:27], a[220:223], a[56:59], v[24:27]
  v_fma_f32 v250, v86, v250, v78
  v_fma_f32 v251, v87, v251, v79
  v_mfma_f32_16x16x32_bf16 v[28:31], a[220:223], a[60:63], v[28:31]
  buffer_load_dwordx4 a[220:223], v7, s[24:27], s67 offen
  s_waitcnt vmcnt(19)
  v_mfma_f32_16x16x32_bf16 v[16:19], a[224:227], a[64:67], v[16:19]
  v_cvt_pk_bf16_f32 v58, v248, v249
  v_cvt_pk_bf16_f32 v59, v250, v251
  v_mfma_f32_16x16x32_bf16 v[20:23], a[224:227], a[68:71], v[20:23]
  ds_write_b64 v8, v[58:59] offset:41472
  v_lshlrev_b32 v72, 16, v64
  v_mfma_f32_16x16x32_bf16 v[24:27], a[224:227], a[72:75], v[24:27]
  v_and_b32 v73, s50, v64
  v_lshlrev_b32 v74, 16, v65
  v_mfma_f32_16x16x32_bf16 v[28:31], a[224:227], a[76:79], v[28:31]
  buffer_load_dwordx4 a[224:227], v7, s[24:27], s68 offen
  v_and_b32 v75, s50, v65
  v_mfma_f32_16x16x32_bf16 v[16:19], a[228:231], a[80:83], v[16:19]
  v_fma_f32 v32, v88, v32, v72
  v_fma_f32 v33, v89, v33, v73
  v_mfma_f32_16x16x32_bf16 v[20:23], a[228:231], a[84:87], v[20:23]
  v_fma_f32 v34, v90, v34, v74
  v_fma_f32 v35, v91, v35, v75
  v_mfma_f32_16x16x32_bf16 v[24:27], a[228:231], a[88:91], v[24:27]
  v_cvt_pk_bf16_f32 v64, v32, v33
  v_cvt_pk_bf16_f32 v65, v34, v35
  v_mfma_f32_16x16x32_bf16 v[28:31], a[228:231], a[92:95], v[28:31]
  buffer_load_dwordx4 a[228:231], v7, s[24:27], s69 offen
  s_waitcnt vmcnt(17)
  v_mfma_f32_16x16x32_bf16 v[16:19], a[232:235], a[96:99], v[16:19]
  ds_write_b64 v10, v[64:65] offset:13824
  v_lshlrev_b32 v76, 16, v66
  v_mfma_f32_16x16x32_bf16 v[20:23], a[232:235], a[100:103], v[20:23]
  v_and_b32 v77, s50, v66
  v_lshlrev_b32 v78, 16, v67
  v_mfma_f32_16x16x32_bf16 v[24:27], a[232:235], a[104:107], v[24:27]
  v_and_b32 v79, s50, v67
  v_fma_f32 v36, v92, v36, v76
  v_mfma_f32_16x16x32_bf16 v[28:31], a[232:235], a[108:111], v[28:31]
  buffer_load_dwordx4 a[232:235], v7, s[24:27], s70 offen
  v_fma_f32 v37, v93, v37, v77
  v_mfma_f32_16x16x32_bf16 v[16:19], a[236:239], a[112:115], v[16:19]
  v_fma_f32 v38, v94, v38, v78
  v_fma_f32 v39, v95, v39, v79
  v_mfma_f32_16x16x32_bf16 v[20:23], a[236:239], a[116:119], v[20:23]
  v_cvt_pk_bf16_f32 v66, v36, v37
  v_cvt_pk_bf16_f32 v67, v38, v39
  v_mfma_f32_16x16x32_bf16 v[24:27], a[236:239], a[120:123], v[24:27]
  ds_write_b64 v10, v[66:67] offset:41472
  v_lshlrev_b32 v72, 16, v68
  v_mfma_f32_16x16x32_bf16 v[28:31], a[236:239], a[124:127], v[28:31]
  buffer_load_dwordx4 a[236:239], v7, s[24:27], s71 offen
  s_waitcnt vmcnt(15)
  v_mfma_f32_16x16x32_bf16 v[16:19], a[240:243], a[128:131], v[16:19]
  v_and_b32 v73, s50, v68
  v_lshlrev_b32 v74, 16, v69
  v_mfma_f32_16x16x32_bf16 v[20:23], a[240:243], a[132:135], v[20:23]
  v_and_b32 v75, s50, v69
  v_fma_f32 v40, v96, v40, v72
  v_mfma_f32_16x16x32_bf16 v[24:27], a[240:243], a[136:139], v[24:27]
  v_fma_f32 v41, v97, v41, v73
  v_fma_f32 v42, v98, v42, v74
  v_mfma_f32_16x16x32_bf16 v[28:31], a[240:243], a[140:143], v[28:31]
  buffer_load_dwordx4 a[240:243], v7, s[24:27], s72 offen
  v_fma_f32 v43, v99, v43, v75
  v_mfma_f32_16x16x32_bf16 v[16:19], a[244:247], a[144:147], v[16:19]
  v_cvt_pk_bf16_f32 v68, v40, v41
  v_cvt_pk_bf16_f32 v69, v42, v43
  v_mfma_f32_16x16x32_bf16 v[20:23], a[244:247], a[148:151], v[20:23]
  ds_write_b64 v11, v[68:69] offset:13824
  v_lshlrev_b32 v76, 16, v70
  v_mfma_f32_16x16x32_bf16 v[24:27], a[244:247], a[152:155], v[24:27]
  v_and_b32 v77, s50, v70
  v_lshlrev_b32 v78, 16, v71
  v_mfma_f32_16x16x32_bf16 v[28:31], a[244:247], a[156:159], v[28:31]
  buffer_load_dwordx4 a[244:247], v7, s[24:27], s73 offen
  s_waitcnt vmcnt(13)
  v_mfma_f32_16x16x32_bf16 v[16:19], a[248:251], a[160:163], v[16:19]
  v_and_b32 v79, s50, v71
  v_fma_f32 v44, v100, v44, v76
  v_mfma_f32_16x16x32_bf16 v[20:23], a[248:251], a[164:167], v[20:23]
  v_fma_f32 v45, v101, v45, v77
  v_fma_f32 v46, v102, v46, v78
  v_mfma_f32_16x16x32_bf16 v[24:27], a[248:251], a[168:171], v[24:27]
  v_fma_f32 v47, v103, v47, v79
  v_cvt_pk_bf16_f32 v70, v44, v45
  v_mfma_f32_16x16x32_bf16 v[28:31], a[248:251], a[172:175], v[28:31]
  buffer_load_dwordx4 a[248:251], v7, s[24:27], s74 offen
  v_cvt_pk_bf16_f32 v71, v46, v47
  v_mfma_f32_16x16x32_bf16 v[16:19], a[252:255], a[176:179], v[16:19]
  ds_write_b64 v11, v[70:71] offset:41472
  v_add_u32 v8, s86, v4
  v_mfma_f32_16x16x32_bf16 v[20:23], a[252:255], a[180:183], v[20:23]
  v_add_u32 v9, s86, v5
  ds_read_b64 v[56:57], v8 offset:0
  v_mfma_f32_16x16x32_bf16 v[24:27], a[252:255], a[184:187], v[24:27]
  ds_read_b64 v[58:59], v8 offset:27648
  ds_read_b64 v[60:61], v9 offset:0
  v_mfma_f32_16x16x32_bf16 v[28:31], a[252:255], a[188:191], v[28:31]
  buffer_load_dwordx4 a[252:255], v7, s[24:27], s75 offen
  s_waitcnt vmcnt(13)
  v_mfma_f32_16x16x32_bf16 v[16:19], v[184:187], a[192:195], v[16:19]
  ds_read_b64 v[62:63], v9 offset:27648
  v_add_u32 v240, s94, v6
  v_mfma_f32_16x16x32_bf16 v[20:23], v[184:187], a[196:199], v[20:23]
  ds_read_b128 v[52:55], v240 offset:0
  v_mfma_f32_16x16x32_bf16 v[24:27], v[184:187], a[200:203], v[24:27]
  v_mfma_f32_16x16x32_bf16 v[28:31], v[184:187], a[204:207], v[28:31]
  buffer_load_dwordx4 v[184:187], v7, s[24:27], s76 offen
  s_add_u32 s33, s34, s82
  v_add_u32 v7, s33, v1
  s_waitcnt lgkmcnt(0)
  v_mfma_f32_16x16x32_bf16 v[32:35], v[188:191], a[0:3], v[52:55]
  v_mfma_f32_16x16x32_bf16 v[36:39], v[188:191], a[4:7], v[52:55]
  v_mfma_f32_16x16x32_bf16 v[40:43], v[188:191], a[8:11], v[52:55]
  v_mfma_f32_16x16x32_bf16 v[44:47], v[188:191], a[12:15], v[52:55]
  buffer_load_dwordx4 v[188:191], v7, s[24:27], s64 offen
  v_mfma_f32_16x16x32_bf16 v[32:35], v[192:195], a[16:19], v[32:35]
  v_lshlrev_b32 v72, 16, v56
  v_and_b32 v73, s50, v56
  v_mfma_f32_16x16x32_bf16 v[36:39], v[192:195], a[20:23], v[36:39]
  v_lshlrev_b32 v74, 16, v57
  v_and_b32 v75, s50, v57
  v_mfma_f32_16x16x32_bf16 v[40:43], v[192:195], a[24:27], v[40:43]
  v_fma_f32 v16, v104, v16, v72
  v_fma_f32 v17, v105, v17, v73
  v_mfma_f32_16x16x32_bf16 v[44:47], v[192:195], a[28:31], v[44:47]
  buffer_load_dwordx4 v[192:195], v7, s[24:27], s65 offen
  v_mfma_f32_16x16x32_bf16 v[32:35], v[196:199], a[32:35], v[32:35]
  v_fma_f32 v18, v106, v18, v74
  v_fma_f32 v19, v107, v19, v75
  v_mfma_f32_16x16x32_bf16 v[36:39], v[196:199], a[36:39], v[36:39]
  v_cvt_pk_bf16_f32 v56, v16, v17
  v_cvt_pk_bf16_f32 v57, v18, v19
  v_mfma_f32_16x16x32_bf16 v[40:43], v[196:199], a[40:43], v[40:43]
  ds_write_b64 v8, v[56:57] offset:13824
  v_lshlrev_b32 v76, 16, v58
  v_mfma_f32_16x16x32_bf16 v[44:47], v[196:199], a[44:47], v[44:47]
  buffer_load_dwordx4 v[196:199], v7, s[24:27], s66 offen
  v_and_b32 v77, s50, v58
  v_mfma_f32_16x16x32_bf16 v[32:35], v[200:203], a[48:51], v[32:35]
  v_lshlrev_b32 v78, 16, v59
  v_and_b32 v79, s50, v59
  v_mfma_f32_16x16x32_bf16 v[36:39], v[200:203], a[52:55], v[36:39]
  v_fma_f32 v20, v108, v20, v76
  v_fma_f32 v21, v109, v21, v77
  v_mfma_f32_16x16x32_bf16 v[40:43], v[200:203], a[56:59], v[40:43]
  v_fma_f32 v22, v110, v22, v78
  v_fma_f32 v23, v111, v23, v79
  v_mfma_f32_16x16x32_bf16 v[44:47], v[200:203], a[60:63], v[44:47]
  buffer_load_dwordx4 v[200:203], v7, s[24:27], s67 offen
  v_mfma_f32_16x16x32_bf16 v[32:35], v[204:207], a[64:67], v[32:35]
  v_cvt_pk_bf16_f32 v58, v20, v21
  v_cvt_pk_bf16_f32 v59, v22, v23
  v_mfma_f32_16x16x32_bf16 v[36:39], v[204:207], a[68:71], v[36:39]
  ds_write_b64 v8, v[58:59] offset:41472
  v_lshlrev_b32 v72, 16, v60
  v_mfma_f32_16x16x32_bf16 v[40:43], v[204:207], a[72:75], v[40:43]
  v_and_b32 v73, s50, v60
  v_lshlrev_b32 v74, 16, v61
  v_mfma_f32_16x16x32_bf16 v[44:47], v[204:207], a[76:79], v[44:47]
  buffer_load_dwordx4 v[204:207], v7, s[24:27], s68 offen
  v_and_b32 v75, s50, v61
  v_mfma_f32_16x16x32_bf16 v[32:35], v[208:211], a[80:83], v[32:35]
  v_fma_f32 v24, v112, v24, v72
  v_fma_f32 v25, v113, v25, v73
  v_mfma_f32_16x16x32_bf16 v[36:39], v[208:211], a[84:87], v[36:39]
  v_fma_f32 v26, v114, v26, v74
  v_fma_f32 v27, v115, v27, v75
  v_mfma_f32_16x16x32_bf16 v[40:43], v[208:211], a[88:91], v[40:43]
  v_cvt_pk_bf16_f32 v60, v24, v25
  v_cvt_pk_bf16_f32 v61, v26, v27
  v_mfma_f32_16x16x32_bf16 v[44:47], v[208:211], a[92:95], v[44:47]
  buffer_load_dwordx4 v[208:211], v7, s[24:27], s69 offen
  v_mfma_f32_16x16x32_bf16 v[32:35], v[212:215], a[96:99], v[32:35]
  ds_write_b64 v9, v[60:61] offset:13824
  v_lshlrev_b32 v76, 16, v62
  v_mfma_f32_16x16x32_bf16 v[36:39], v[212:215], a[100:103], v[36:39]
  v_and_b32 v77, s50, v62
  v_lshlrev_b32 v78, 16, v63
  v_mfma_f32_16x16x32_bf16 v[40:43], v[212:215], a[104:107], v[40:43]
  v_and_b32 v79, s50, v63
  v_fma_f32 v28, v116, v28, v76
  v_mfma_f32_16x16x32_bf16 v[44:47], v[212:215], a[108:111], v[44:47]
  buffer_load_dwordx4 v[212:215], v7, s[24:27], s70 offen
  v_fma_f32 v29, v117, v29, v77
  v_mfma_f32_16x16x32_bf16 v[32:35], v[216:219], a[112:115], v[32:35]
  v_fma_f32 v30, v118, v30, v78
  v_fma_f32 v31, v119, v31, v79
  v_mfma_f32_16x16x32_bf16 v[36:39], v[216:219], a[116:119], v[36:39]
  v_cvt_pk_bf16_f32 v62, v28, v29
  v_cvt_pk_bf16_f32 v63, v30, v31
  v_mfma_f32_16x16x32_bf16 v[40:43], v[216:219], a[120:123], v[40:43]
  ds_write_b64 v9, v[62:63] offset:41472
  v_add_u32 v10, s87, v4
  v_mfma_f32_16x16x32_bf16 v[44:47], v[216:219], a[124:127], v[44:47]
  buffer_load_dwordx4 v[216:219], v7, s[24:27], s71 offen
  v_mfma_f32_16x16x32_bf16 v[32:35], v[220:223], a[128:131], v[32:35]
  v_add_u32 v11, s87, v5
  ds_read_b64 v[64:65], v10 offset:0
  v_mfma_f32_16x16x32_bf16 v[36:39], v[220:223], a[132:135], v[36:39]
  ds_read_b64 v[66:67], v10 offset:27648
  ds_read_b64 v[68:69], v11 offset:0
  v_mfma_f32_16x16x32_bf16 v[40:43], v[220:223], a[136:139], v[40:43]
  ds_read_b64 v[70:71], v11 offset:27648
  v_add_u32 v240, s95, v6
  v_mfma_f32_16x16x32_bf16 v[44:47], v[220:223], a[140:143], v[44:47]
  buffer_load_dwordx4 v[220:223], v7, s[24:27], s72 offen
  ds_read_b128 v[48:51], v240 offset:0
  v_mfma_f32_16x16x32_bf16 v[32:35], v[224:227], a[144:147], v[32:35]
  v_mfma_f32_16x16x32_bf16 v[36:39], v[224:227], a[148:151], v[36:39]
  v_mfma_f32_16x16x32_bf16 v[40:43], v[224:227], a[152:155], v[40:43]
  v_mfma_f32_16x16x32_bf16 v[44:47], v[224:227], a[156:159], v[44:47]
  buffer_load_dwordx4 v[224:227], v7, s[24:27], s73 offen
  v_mfma_f32_16x16x32_bf16 v[32:35], v[228:231], a[160:163], v[32:35]
  v_mfma_f32_16x16x32_bf16 v[36:39], v[228:231], a[164:167], v[36:39]
  v_mfma_f32_16x16x32_bf16 v[40:43], v[228:231], a[168:171], v[40:43]
  v_mfma_f32_16x16x32_bf16 v[44:47], v[228:231], a[172:175], v[44:47]
  buffer_load_dwordx4 v[228:231], v7, s[24:27], s74 offen
  v_mfma_f32_16x16x32_bf16 v[32:35], v[232:235], a[176:179], v[32:35]
  v_mfma_f32_16x16x32_bf16 v[36:39], v[232:235], a[180:183], v[36:39]
  v_mfma_f32_16x16x32_bf16 v[40:43], v[232:235], a[184:187], v[40:43]
  v_mfma_f32_16x16x32_bf16 v[44:47], v[232:235], a[188:191], v[44:47]
  buffer_load_dwordx4 v[232:235], v7, s[24:27], s75 offen
  s_waitcnt vmcnt(25)
  v_mfma_f32_16x16x32_bf16 v[32:35], v[236:239], a[192:195], v[32:35]
  v_mfma_f32_16x16x32_bf16 v[36:39], v[236:239], a[196:199], v[36:39]
  v_mfma_f32_16x16x32_bf16 v[40:43], v[236:239], a[200:203], v[40:43]
  v_mfma_f32_16x16x32_bf16 v[44:47], v[236:239], a[204:207], v[44:47]
  buffer_load_dwordx4 v[236:239], v7, s[24:27], s76 offen
  s_add_u32 s33, s34, s83
  v_add_u32 v7, s33, v1
  s_waitcnt vmcnt(24) lgkmcnt(0)
  v_mfma_f32_16x16x32_bf16 v[16:19], a[208:211], a[0:3], v[48:51]
  v_mfma_f32_16x16x32_bf16 v[20:23], a[208:211], a[4:7], v[48:51]
  v_mfma_f32_16x16x32_bf16 v[24:27], a[208:211], a[8:11], v[48:51]
  v_mfma_f32_16x16x32_bf16 v[28:31], a[208:211], a[12:15], v[48:51]
  buffer_load_dwordx4 a[208:211], v7, s[24:27], s64 offen
  v_mfma_f32_16x16x32_bf16 v[16:19], a[212:215], a[16:19], v[16:19]
  v_lshlrev_b32 v72, 16, v64
  v_and_b32 v73, s50, v64
  v_mfma_f32_16x16x32_bf16 v[20:23], a[212:215], a[20:23], v[20:23]
  v_lshlrev_b32 v74, 16, v65
  v_and_b32 v75, s50, v65
  v_mfma_f32_16x16x32_bf16 v[24:27], a[212:215], a[24:27], v[24:27]
  v_fma_f32 v32, v120, v32, v72
  v_fma_f32 v33, v121, v33, v73
  v_mfma_f32_16x16x32_bf16 v[28:31], a[212:215], a[28:31], v[28:31]
  buffer_load_dwordx4 a[212:215], v7, s[24:27], s65 offen
  s_waitcnt vmcnt(24)
  v_mfma_f32_16x16x32_bf16 v[16:19], a[216:219], a[32:35], v[16:19]
  v_fma_f32 v34, v122, v34, v74
  v_fma_f32 v35, v123, v35, v75
  v_mfma_f32_16x16x32_bf16 v[20:23], a[216:219], a[36:39], v[20:23]
  v_cvt_pk_bf16_f32 v64, v32, v33
  v_cvt_pk_bf16_f32 v65, v34, v35
  v_mfma_f32_16x16x32_bf16 v[24:27], a[216:219], a[40:43], v[24:27]
  ds_write_b64 v10, v[64:65] offset:13824
  v_lshlrev_b32 v76, 16, v66
  v_mfma_f32_16x16x32_bf16 v[28:31], a[216:219], a[44:47], v[28:31]
  buffer_load_dwordx4 a[216:219], v7, s[24:27], s66 offen
  v_and_b32 v77, s50, v66
  v_mfma_f32_16x16x32_bf16 v[16:19], a[220:223], a[48:51], v[16:19]
  v_lshlrev_b32 v78, 16, v67
  v_and_b32 v79, s50, v67
  v_mfma_f32_16x16x32_bf16 v[20:23], a[220:223], a[52:55], v[20:23]
  v_fma_f32 v36, v124, v36, v76
  v_fma_f32 v37, v125, v37, v77
  v_mfma_f32_16x16x32_bf16 v[24:27], a[220:223], a[56:59], v[24:27]
  v_fma_f32 v38, v126, v38, v78
  v_fma_f32 v39, v127, v39, v79
  v_mfma_f32_16x16x32_bf16 v[28:31], a[220:223], a[60:63], v[28:31]
  buffer_load_dwordx4 a[220:223], v7, s[24:27], s67 offen
  s_waitcnt vmcnt(24)
  v_mfma_f32_16x16x32_bf16 v[16:19], a[224:227], a[64:67], v[16:19]
  v_cvt_pk_bf16_f32 v66, v36, v37
  v_cvt_pk_bf16_f32 v67, v38, v39
  v_mfma_f32_16x16x32_bf16 v[20:23], a[224:227], a[68:71], v[20:23]
  ds_write_b64 v10, v[66:67] offset:41472
  v_lshlrev_b32 v72, 16, v68
  v_mfma_f32_16x16x32_bf16 v[24:27], a[224:227], a[72:75], v[24:27]
  v_and_b32 v73, s50, v68
  v_lshlrev_b32 v74, 16, v69
  v_mfma_f32_16x16x32_bf16 v[28:31], a[224:227], a[76:79], v[28:31]
  buffer_load_dwordx4 a[224:227], v7, s[24:27], s68 offen
  v_and_b32 v75, s50, v69
  v_mfma_f32_16x16x32_bf16 v[16:19], a[228:231], a[80:83], v[16:19]
  v_fma_f32 v40, v128, v40, v72
  v_fma_f32 v41, v129, v41, v73
  v_mfma_f32_16x16x32_bf16 v[20:23], a[228:231], a[84:87], v[20:23]
  v_fma_f32 v42, v130, v42, v74
  v_fma_f32 v43, v131, v43, v75
  v_mfma_f32_16x16x32_bf16 v[24:27], a[228:231], a[88:91], v[24:27]
  v_cvt_pk_bf16_f32 v68, v40, v41
  v_cvt_pk_bf16_f32 v69, v42, v43
  v_mfma_f32_16x16x32_bf16 v[28:31], a[228:231], a[92:95], v[28:31]
  buffer_load_dwordx4 a[228:231], v7, s[24:27], s69 offen
  s_waitcnt vmcnt(24)
  v_mfma_f32_16x16x32_bf16 v[16:19], a[232:235], a[96:99], v[16:19]
  ds_write_b64 v11, v[68:69] offset:13824
  v_lshlrev_b32 v76, 16, v70
  v_mfma_f32_16x16x32_bf16 v[20:23], a[232:235], a[100:103], v[20:23]
  v_and_b32 v77, s50, v70
  v_lshlrev_b32 v78, 16, v71
  v_mfma_f32_16x16x32_bf16 v[24:27], a[232:235], a[104:107], v[24:27]
  v_and_b32 v79, s50, v71
  v_fma_f32 v44, v132, v44, v76
  v_mfma_f32_16x16x32_bf16 v[28:31], a[232:235], a[108:111], v[28:31]
  buffer_load_dwordx4 a[232:235], v7, s[24:27], s70 offen
  v_fma_f32 v45, v133, v45, v77
  v_mfma_f32_16x16x32_bf16 v[16:19], a[236:239], a[112:115], v[16:19]
  v_fma_f32 v46, v134, v46, v78
  v_fma_f32 v47, v135, v47, v79
  v_mfma_f32_16x16x32_bf16 v[20:23], a[236:239], a[116:119], v[20:23]
  v_cvt_pk_bf16_f32 v70, v44, v45
  v_cvt_pk_bf16_f32 v71, v46, v47
  v_mfma_f32_16x16x32_bf16 v[24:27], a[236:239], a[120:123], v[24:27]
  ds_write_b64 v11, v[70:71] offset:41472
  v_add_u32 v8, s88, v4
  v_mfma_f32_16x16x32_bf16 v[28:31], a[236:239], a[124:127], v[28:31]
  buffer_load_dwordx4 a[236:239], v7, s[24:27], s71 offen
  s_waitcnt vmcnt(24)
  v_mfma_f32_16x16x32_bf16 v[16:19], a[240:243], a[128:131], v[16:19]
  v_add_u32 v9, s88, v5
  ds_read_b64 v[56:57], v8 offset:0
  v_mfma_f32_16x16x32_bf16 v[20:23], a[240:243], a[132:135], v[20:23]
  ds_read_b64 v[58:59], v8 offset:27648
  ds_read_b64 v[60:61], v9 offset:0
  v_mfma_f32_16x16x32_bf16 v[24:27], a[240:243], a[136:139], v[24:27]
  ds_read_b64 v[62:63], v9 offset:27648
  v_add_u32 v240, s96, v6
  v_mfma_f32_16x16x32_bf16 v[28:31], a[240:243], a[140:143], v[28:31]
  buffer_load_dwordx4 a[240:243], v7, s[24:27], s72 offen
  ds_read_b128 v[52:55], v240 offset:0
  v_mfma_f32_16x16x32_bf16 v[16:19], a[244:247], a[144:147], v[16:19]
  v_mfma_f32_16x16x32_bf16 v[20:23], a[244:247], a[148:151], v[20:23]
  v_mfma_f32_16x16x32_bf16 v[24:27], a[244:247], a[152:155], v[24:27]
  v_mfma_f32_16x16x32_bf16 v[28:31], a[244:247], a[156:159], v[28:31]
  buffer_load_dwordx4 a[244:247], v7, s[24:27], s73 offen
  s_waitcnt vmcnt(24)
  v_mfma_f32_16x16x32_bf16 v[16:19], a[248:251], a[160:163], v[16:19]
  v_mfma_f32_16x16x32_bf16 v[20:23], a[248:251], a[164:167], v[20:23]
  v_mfma_f32_16x16x32_bf16 v[24:27], a[248:251], a[168:171], v[24:27]
  v_mfma_f32_16x16x32_bf16 v[28:31], a[248:251], a[172:175], v[28:31]
  buffer_load_dwordx4 a[248:251], v7, s[24:27], s74 offen
  v_mfma_f32_16x16x32_bf16 v[16:19], a[252:255], a[176:179], v[16:19]
  v_mfma_f32_16x16x32_bf16 v[20:23], a[252:255], a[180:183], v[20:23]
  v_mfma_f32_16x16x32_bf16 v[24:27], a[252:255], a[184:187], v[24:27]
  v_mfma_f32_16x16x32_bf16 v[28:31], a[252:255], a[188:191], v[28:31]
  buffer_load_dwordx4 a[252:255], v7, s[24:27], s75 offen
  s_waitcnt vmcnt(25)
  v_mfma_f32_16x16x32_bf16 v[16:19], v[184:187], a[192:195], v[16:19]
  v_mfma_f32_16x16x32_bf16 v[20:23], v[184:187], a[196:199], v[20:23]
  v_mfma_f32_16x16x32_bf16 v[24:27], v[184:187], a[200:203], v[24:27]
  v_mfma_f32_16x16x32_bf16 v[28:31], v[184:187], a[204:207], v[28:31]
  buffer_load_dwordx4 v[184:187], v7, s[24:27], s76 offen
  s_add_u32 s34, s34, 346112
  s_add_u32 s33, s34, s77
  v_add_u32 v7, s33, v1
  s_waitcnt vmcnt(24) lgkmcnt(0)
  v_mfma_f32_16x16x32_bf16 v[32:35], v[188:191], a[0:3], v[52:55]
  v_mfma_f32_16x16x32_bf16 v[36:39], v[188:191], a[4:7], v[52:55]
  v_mfma_f32_16x16x32_bf16 v[40:43], v[188:191], a[8:11], v[52:55]
  v_mfma_f32_16x16x32_bf16 v[44:47], v[188:191], a[12:15], v[52:55]
  buffer_load_dwordx4 v[188:191], v7, s[24:27], s64 offen
  v_lshlrev_b32 v72, 16, v56
  v_mfma_f32_16x16x32_bf16 v[32:35], v[192:195], a[16:19], v[32:35]
  v_and_b32 v73, s50, v56
  v_lshlrev_b32 v74, 16, v57
  v_mfma_f32_16x16x32_bf16 v[36:39], v[192:195], a[20:23], v[36:39]
  v_and_b32 v75, s50, v57
  v_fma_f32 v16, v136, v16, v72
  v_mfma_f32_16x16x32_bf16 v[40:43], v[192:195], a[24:27], v[40:43]
  v_fma_f32 v17, v137, v17, v73
  v_fma_f32 v18, v138, v18, v74
  v_mfma_f32_16x16x32_bf16 v[44:47], v[192:195], a[28:31], v[44:47]
  buffer_load_dwordx4 v[192:195], v7, s[24:27], s65 offen
  s_waitcnt vmcnt(24)
  v_mfma_f32_16x16x32_bf16 v[32:35], v[196:199], a[32:35], v[32:35]
  v_fma_f32 v19, v139, v19, v75
  v_cvt_pk_bf16_f32 v56, v16, v17
  v_mfma_f32_16x16x32_bf16 v[36:39], v[196:199], a[36:39], v[36:39]
  v_cvt_pk_bf16_f32 v57, v18, v19
  ds_write_b64 v8, v[56:57] offset:13824
  v_mfma_f32_16x16x32_bf16 v[40:43], v[196:199], a[40:43], v[40:43]
  v_lshlrev_b32 v76, 16, v58
  v_and_b32 v77, s50, v58
  v_mfma_f32_16x16x32_bf16 v[44:47], v[196:199], a[44:47], v[44:47]
  buffer_load_dwordx4 v[196:199], v7, s[24:27], s66 offen
  v_lshlrev_b32 v78, 16, v59
  v_mfma_f32_16x16x32_bf16 v[32:35], v[200:203], a[48:51], v[32:35]
  v_and_b32 v79, s50, v59
  v_fma_f32 v20, v140, v20, v76
  v_mfma_f32_16x16x32_bf16 v[36:39], v[200:203], a[52:55], v[36:39]
  v_fma_f32 v21, v141, v21, v77
  v_fma_f32 v22, v142, v22, v78
  v_mfma_f32_16x16x32_bf16 v[40:43], v[200:203], a[56:59], v[40:43]
  v_fma_f32 v23, v143, v23, v79
  v_cvt_pk_bf16_f32 v58, v20, v21
  v_mfma_f32_16x16x32_bf16 v[44:47], v[200:203], a[60:63], v[44:47]
  buffer_load_dwordx4 v[200:203], v7, s[24:27], s67 offen
  s_waitcnt vmcnt(24)
  v_mfma_f32_16x16x32_bf16 v[32:35], v[204:207], a[64:67], v[32:35]
  v_cvt_pk_bf16_f32 v59, v22, v23
  ds_write_b64 v8, v[58:59] offset:41472
  v_mfma_f32_16x16x32_bf16 v[36:39], v[204:207], a[68:71], v[36:39]
  v_lshlrev_b32 v72, 16, v60
  v_and_b32 v73, s50, v60
  v_mfma_f32_16x16x32_bf16 v[40:43], v[204:207], a[72:75], v[40:43]
  v_lshlrev_b32 v74, 16, v61
  v_and_b32 v75, s50, v61
  v_mfma_f32_16x16x32_bf16 v[44:47], v[204:207], a[76:79], v[44:47]
  buffer_load_dwordx4 v[204:207], v7, s[24:27], s68 offen
  v_fma_f32 v24, v144, v24, v72
  v_mfma_f32_16x16x32_bf16 v[32:35], v[208:211], a[80:83], v[32:35]
  v_fma_f32 v25, v145, v25, v73
  v_fma_f32 v26, v146, v26, v74
  v_mfma_f32_16x16x32_bf16 v[36:39], v[208:211], a[84:87], v[36:39]
  v_fma_f32 v27, v147, v27, v75
  v_cvt_pk_bf16_f32 v60, v24, v25
  v_mfma_f32_16x16x32_bf16 v[40:43], v[208:211], a[88:91], v[40:43]
  v_cvt_pk_bf16_f32 v61, v26, v27
  ds_write_b64 v9, v[60:61] offset:13824
  v_mfma_f32_16x16x32_bf16 v[44:47], v[208:211], a[92:95], v[44:47]
  buffer_load_dwordx4 v[208:211], v7, s[24:27], s69 offen
  s_waitcnt vmcnt(24)
  v_mfma_f32_16x16x32_bf16 v[32:35], v[212:215], a[96:99], v[32:35]
  v_lshlrev_b32 v76, 16, v62
  v_and_b32 v77, s50, v62
  v_mfma_f32_16x16x32_bf16 v[36:39], v[212:215], a[100:103], v[36:39]
  v_lshlrev_b32 v78, 16, v63
  v_and_b32 v79, s50, v63
  v_mfma_f32_16x16x32_bf16 v[40:43], v[212:215], a[104:107], v[40:43]
  v_fma_f32 v28, v148, v28, v76
  v_fma_f32 v29, v149, v29, v77
  v_mfma_f32_16x16x32_bf16 v[44:47], v[212:215], a[108:111], v[44:47]
  buffer_load_dwordx4 v[212:215], v7, s[24:27], s70 offen
  v_fma_f32 v30, v150, v30, v78
  v_mfma_f32_16x16x32_bf16 v[32:35], v[216:219], a[112:115], v[32:35]
  v_fma_f32 v31, v151, v31, v79
  v_cvt_pk_bf16_f32 v62, v28, v29
  v_mfma_f32_16x16x32_bf16 v[36:39], v[216:219], a[116:119], v[36:39]
  v_cvt_pk_bf16_f32 v63, v30, v31
  ds_write_b64 v9, v[62:63] offset:41472
  v_mfma_f32_16x16x32_bf16 v[40:43], v[216:219], a[120:123], v[40:43]
  v_add_u32 v10, s89, v4
  v_add_u32 v11, s89, v5
  v_mfma_f32_16x16x32_bf16 v[44:47], v[216:219], a[124:127], v[44:47]
  buffer_load_dwordx4 v[216:219], v7, s[24:27], s71 offen
  s_waitcnt vmcnt(24)
  v_mfma_f32_16x16x32_bf16 v[32:35], v[220:223], a[128:131], v[32:35]
  ds_read_b64 v[64:65], v10 offset:0
  ds_read_b64 v[66:67], v10 offset:27648
  v_mfma_f32_16x16x32_bf16 v[36:39], v[220:223], a[132:135], v[36:39]
  ds_read_b64 v[68:69], v11 offset:0
  ds_read_b64 v[70:71], v11 offset:27648
  v_mfma_f32_16x16x32_bf16 v[40:43], v[220:223], a[136:139], v[40:43]
  v_add_u32 v240, s97, v6
  ds_read_b128 v[48:51], v240 offset:0
  v_mfma_f32_16x16x32_bf16 v[44:47], v[220:223], a[140:143], v[44:47]
  buffer_load_dwordx4 v[220:223], v7, s[24:27], s72 offen
  v_mfma_f32_16x16x32_bf16 v[32:35], v[224:227], a[144:147], v[32:35]
  v_mfma_f32_16x16x32_bf16 v[36:39], v[224:227], a[148:151], v[36:39]
  v_mfma_f32_16x16x32_bf16 v[40:43], v[224:227], a[152:155], v[40:43]
  v_mfma_f32_16x16x32_bf16 v[44:47], v[224:227], a[156:159], v[44:47]
  buffer_load_dwordx4 v[224:227], v7, s[24:27], s73 offen
  s_waitcnt vmcnt(24)
  v_mfma_f32_16x16x32_bf16 v[32:35], v[228:231], a[160:163], v[32:35]
  v_mfma_f32_16x16x32_bf16 v[36:39], v[228:231], a[164:167], v[36:39]
  v_mfma_f32_16x16x32_bf16 v[40:43], v[228:231], a[168:171], v[40:43]
  v_mfma_f32_16x16x32_bf16 v[44:47], v[228:231], a[172:175], v[44:47]
  buffer_load_dwordx4 v[228:231], v7, s[24:27], s74 offen
  v_mfma_f32_16x16x32_bf16 v[32:35], v[232:235], a[176:179], v[32:35]
  v_mfma_f32_16x16x32_bf16 v[36:39], v[232:235], a[180:183], v[36:39]
  v_mfma_f32_16x16x32_bf16 v[40:43], v[232:235], a[184:187], v[40:43]
  v_mfma_f32_16x16x32_bf16 v[44:47], v[232:235], a[188:191], v[44:47]
  buffer_load_dwordx4 v[232:235], v7, s[24:27], s75 offen
  s_waitcnt vmcnt(25)
  v_mfma_f32_16x16x32_bf16 v[32:35], v[236:239], a[192:195], v[32:35]
  v_mfma_f32_16x16x32_bf16 v[36:39], v[236:239], a[196:199], v[36:39]
  v_mfma_f32_16x16x32_bf16 v[40:43], v[236:239], a[200:203], v[40:43]
  v_mfma_f32_16x16x32_bf16 v[44:47], v[236:239], a[204:207], v[44:47]
  buffer_load_dwordx4 v[236:239], v7, s[24:27], s76 offen
  s_add_u32 s33, s34, s78
  v_add_u32 v7, s33, v1
  s_waitcnt vmcnt(24) lgkmcnt(0)
  v_mfma_f32_16x16x32_bf16 v[16:19], a[208:211], a[0:3], v[48:51]
  v_mfma_f32_16x16x32_bf16 v[20:23], a[208:211], a[4:7], v[48:51]
  v_mfma_f32_16x16x32_bf16 v[24:27], a[208:211], a[8:11], v[48:51]
  v_mfma_f32_16x16x32_bf16 v[28:31], a[208:211], a[12:15], v[48:51]
  buffer_load_dwordx4 a[208:211], v7, s[24:27], s64 offen
  v_mfma_f32_16x16x32_bf16 v[16:19], a[212:215], a[16:19], v[16:19]
  v_lshlrev_b32 v72, 16, v64
  v_and_b32 v73, s50, v64
  v_mfma_f32_16x16x32_bf16 v[20:23], a[212:215], a[20:23], v[20:23]
  v_lshlrev_b32 v74, 16, v65
  v_and_b32 v75, s50, v65
  v_mfma_f32_16x16x32_bf16 v[24:27], a[212:215], a[24:27], v[24:27]
  v_fma_f32 v32, v152, v32, v72
  v_fma_f32 v33, v153, v33, v73
  v_mfma_f32_16x16x32_bf16 v[28:31], a[212:215], a[28:31], v[28:31]
  buffer_load_dwordx4 a[212:215], v7, s[24:27], s65 offen
  s_waitcnt vmcnt(24)
  v_mfma_f32_16x16x32_bf16 v[16:19], a[216:219], a[32:35], v[16:19]
  v_fma_f32 v34, v154, v34, v74
  v_fma_f32 v35, v155, v35, v75
  v_mfma_f32_16x16x32_bf16 v[20:23], a[216:219], a[36:39], v[20:23]
  v_cvt_pk_bf16_f32 v64, v32, v33
  v_cvt_pk_bf16_f32 v65, v34, v35
  v_mfma_f32_16x16x32_bf16 v[24:27], a[216:219], a[40:43], v[24:27]
  ds_write_b64 v10, v[64:65] offset:13824
  v_lshlrev_b32 v76, 16, v66
  v_mfma_f32_16x16x32_bf16 v[28:31], a[216:219], a[44:47], v[28:31]
  buffer_load_dwordx4 a[216:219], v7, s[24:27], s66 offen
  v_and_b32 v77, s50, v66
  v_mfma_f32_16x16x32_bf16 v[16:19], a[220:223], a[48:51], v[16:19]
  v_lshlrev_b32 v78, 16, v67
  v_and_b32 v79, s50, v67
  v_mfma_f32_16x16x32_bf16 v[20:23], a[220:223], a[52:55], v[20:23]
  v_fma_f32 v36, v156, v36, v76
  v_fma_f32 v37, v157, v37, v77
  v_mfma_f32_16x16x32_bf16 v[24:27], a[220:223], a[56:59], v[24:27]
  v_fma_f32 v38, v158, v38, v78
  v_fma_f32 v39, v159, v39, v79
  v_mfma_f32_16x16x32_bf16 v[28:31], a[220:223], a[60:63], v[28:31]
  buffer_load_dwordx4 a[220:223], v7, s[24:27], s67 offen
  s_waitcnt vmcnt(24)
  v_mfma_f32_16x16x32_bf16 v[16:19], a[224:227], a[64:67], v[16:19]
  v_cvt_pk_bf16_f32 v66, v36, v37
  v_cvt_pk_bf16_f32 v67, v38, v39
  v_mfma_f32_16x16x32_bf16 v[20:23], a[224:227], a[68:71], v[20:23]
  ds_write_b64 v10, v[66:67] offset:41472
  v_lshlrev_b32 v72, 16, v68
  v_mfma_f32_16x16x32_bf16 v[24:27], a[224:227], a[72:75], v[24:27]
  v_and_b32 v73, s50, v68
  v_lshlrev_b32 v74, 16, v69
  v_mfma_f32_16x16x32_bf16 v[28:31], a[224:227], a[76:79], v[28:31]
  buffer_load_dwordx4 a[224:227], v7, s[24:27], s68 offen
  v_and_b32 v75, s50, v69
  v_mfma_f32_16x16x32_bf16 v[16:19], a[228:231], a[80:83], v[16:19]
  v_fma_f32 v40, v160, v40, v72
  v_fma_f32 v41, v161, v41, v73
  v_mfma_f32_16x16x32_bf16 v[20:23], a[228:231], a[84:87], v[20:23]
  v_fma_f32 v42, v162, v42, v74
  v_fma_f32 v43, v163, v43, v75
  v_mfma_f32_16x16x32_bf16 v[24:27], a[228:231], a[88:91], v[24:27]
  v_cvt_pk_bf16_f32 v68, v40, v41
  v_cvt_pk_bf16_f32 v69, v42, v43
  v_mfma_f32_16x16x32_bf16 v[28:31], a[228:231], a[92:95], v[28:31]
  buffer_load_dwordx4 a[228:231], v7, s[24:27], s69 offen
  s_waitcnt vmcnt(24)
  v_mfma_f32_16x16x32_bf16 v[16:19], a[232:235], a[96:99], v[16:19]
  ds_write_b64 v11, v[68:69] offset:13824
  v_lshlrev_b32 v76, 16, v70
  v_mfma_f32_16x16x32_bf16 v[20:23], a[232:235], a[100:103], v[20:23]
  v_and_b32 v77, s50, v70
  v_lshlrev_b32 v78, 16, v71
  v_mfma_f32_16x16x32_bf16 v[24:27], a[232:235], a[104:107], v[24:27]
  v_and_b32 v79, s50, v71
  v_fma_f32 v44, v164, v44, v76
  v_mfma_f32_16x16x32_bf16 v[28:31], a[232:235], a[108:111], v[28:31]
  buffer_load_dwordx4 a[232:235], v7, s[24:27], s70 offen
  v_fma_f32 v45, v165, v45, v77
  v_mfma_f32_16x16x32_bf16 v[16:19], a[236:239], a[112:115], v[16:19]
  v_fma_f32 v46, v166, v46, v78
  v_fma_f32 v47, v167, v47, v79
  v_mfma_f32_16x16x32_bf16 v[20:23], a[236:239], a[116:119], v[20:23]
  v_cvt_pk_bf16_f32 v70, v44, v45
  v_cvt_pk_bf16_f32 v71, v46, v47
  v_mfma_f32_16x16x32_bf16 v[24:27], a[236:239], a[120:123], v[24:27]
  ds_write_b64 v11, v[70:71] offset:41472
  v_add_u32 v8, s90, v4
  v_mfma_f32_16x16x32_bf16 v[28:31], a[236:239], a[124:127], v[28:31]
  buffer_load_dwordx4 a[236:239], v7, s[24:27], s71 offen
  s_waitcnt vmcnt(24)
  v_mfma_f32_16x16x32_bf16 v[16:19], a[240:243], a[128:131], v[16:19]
  v_add_u32 v9, s90, v5
  ds_read_b64 v[56:57], v8 offset:0
  v_mfma_f32_16x16x32_bf16 v[20:23], a[240:243], a[132:135], v[20:23]
  ds_read_b64 v[58:59], v8 offset:27648
  ds_read_b64 v[60:61], v9 offset:0
  v_mfma_f32_16x16x32_bf16 v[24:27], a[240:243], a[136:139], v[24:27]
  ds_read_b64 v[62:63], v9 offset:27648
  v_mfma_f32_16x16x32_bf16 v[28:31], a[240:243], a[140:143], v[28:31]
  buffer_load_dwordx4 a[240:243], v7, s[24:27], s72 offen
  v_mfma_f32_16x16x32_bf16 v[16:19], a[244:247], a[144:147], v[16:19]
  v_mfma_f32_16x16x32_bf16 v[20:23], a[244:247], a[148:151], v[20:23]
  v_mfma_f32_16x16x32_bf16 v[24:27], a[244:247], a[152:155], v[24:27]
  v_mfma_f32_16x16x32_bf16 v[28:31], a[244:247], a[156:159], v[28:31]
  buffer_load_dwordx4 a[244:247], v7, s[24:27], s73 offen
  s_waitcnt vmcnt(24)
  v_mfma_f32_16x16x32_bf16 v[16:19], a[248:251], a[160:163], v[16:19]
  v_mfma_f32_16x16x32_bf16 v[20:23], a[248:251], a[164:167], v[20:23]
  v_mfma_f32_16x16x32_bf16 v[24:27], a[248:251], a[168:171], v[24:27]
  v_mfma_f32_16x16x32_bf16 v[28:31], a[248:251], a[172:175], v[28:31]
  buffer_load_dwordx4 a[248:251], v7, s[24:27], s74 offen
  v_mfma_f32_16x16x32_bf16 v[16:19], a[252:255], a[176:179], v[16:19]
  v_mfma_f32_16x16x32_bf16 v[20:23], a[252:255], a[180:183], v[20:23]
  v_mfma_f32_16x16x32_bf16 v[24:27], a[252:255], a[184:187], v[24:27]
  v_mfma_f32_16x16x32_bf16 v[28:31], a[252:255], a[188:191], v[28:31]
  buffer_load_dwordx4 a[252:255], v7, s[24:27], s75 offen
  s_waitcnt vmcnt(25)
  v_mfma_f32_16x16x32_bf16 v[16:19], v[184:187], a[192:195], v[16:19]
  v_mfma_f32_16x16x32_bf16 v[20:23], v[184:187], a[196:199], v[20:23]
  v_mfma_f32_16x16x32_bf16 v[24:27], v[184:187], a[200:203], v[24:27]
  v_mfma_f32_16x16x32_bf16 v[28:31], v[184:187], a[204:207], v[28:31]
  buffer_load_dwordx4 v[184:187], v7, s[24:27], s76 offen
  s_nop 7
  s_nop 0
  s_waitcnt lgkmcnt(0)
  v_lshlrev_b32 v72, 16, v56
  v_and_b32 v73, s50, v56
  v_lshlrev_b32 v74, 16, v57
  v_and_b32 v75, s50, v57
  v_fma_f32 v16, v168, v16, v72
  v_fma_f32 v17, v169, v17, v73
  v_fma_f32 v18, v170, v18, v74
  v_fma_f32 v19, v171, v19, v75
  v_cvt_pk_bf16_f32 v56, v16, v17
  v_cvt_pk_bf16_f32 v57, v18, v19
  ds_write_b64 v8, v[56:57] offset:13824
  v_lshlrev_b32 v76, 16, v58
  v_and_b32 v77, s50, v58
  v_lshlrev_b32 v78, 16, v59
  v_and_b32 v79, s50, v59
  v_fma_f32 v20, v172, v20, v76
  v_fma_f32 v21, v173, v21, v77
  v_fma_f32 v22, v174, v22, v78
  v_fma_f32 v23, v175, v23, v79
  v_cvt_pk_bf16_f32 v58, v20, v21
  v_cvt_pk_bf16_f32 v59, v22, v23
  ds_write_b64 v8, v[58:59] offset:41472
  v_lshlrev_b32 v72, 16, v60
  v_and_b32 v73, s50, v60
  v_lshlrev_b32 v74, 16, v61
  v_and_b32 v75, s50, v61
  v_fma_f32 v24, v176, v24, v72
  v_fma_f32 v25, v177, v25, v73
  v_fma_f32 v26, v178, v26, v74
  v_fma_f32 v27, v179, v27, v75
  v_cvt_pk_bf16_f32 v60, v24, v25
  v_cvt_pk_bf16_f32 v61, v26, v27
  ds_write_b64 v9, v[60:61] offset:13824
  v_lshlrev_b32 v76, 16, v62
  v_and_b32 v77, s50, v62
  v_lshlrev_b32 v78, 16, v63
  v_and_b32 v79, s50, v63
  v_fma_f32 v28, v180, v28, v76
  v_fma_f32 v29, v181, v29, v77
  v_fma_f32 v30, v182, v30, v78
  v_fma_f32 v31, v183, v31, v79
  v_cvt_pk_bf16_f32 v62, v28, v29
  v_cvt_pk_bf16_f32 v63, v30, v31
  ds_write_b64 v9, v[62:63] offset:41472
  s_waitcnt lgkmcnt(0)
  s_barrier
  v_add_u32 v240, s92, v6
  ds_read_b128 v[48:51], v240 offset:1664
  ds_read_b128 a[0:3], v2 offset:13824
  ds_read_b128 a[4:7], v2 offset:41472
  ds_read_b128 a[8:11], v3 offset:13824
  ds_read_b128 a[12:15], v3 offset:41472
  v_add_u32 v240, s91, v6
  ds_read_b128 v[52:55], v240 offset:1664
  ds_read_b128 a[16:19], v2 offset:13888
  ds_read_b128 a[20:23], v2 offset:41536
  ds_read_b128 a[24:27], v3 offset:13888
  ds_read_b128 a[28:31], v3 offset:41536
  ds_read_b128 a[32:35], v2 offset:13952
  ds_read_b128 a[36:39], v2 offset:41600
  s_add_u32 s33, s34, s79
  v_add_u32 v7, s33, v1
  s_add_u32 s33, s34, s80
  v_add_u32 v241, s33, v1
  s_waitcnt vmcnt(11) lgkmcnt(6)
  v_mfma_f32_16x16x32_bf16 v[16:19], a[208:211], a[0:3], v[48:51]
  ds_read_b128 a[40:43], v3 offset:13952
  ds_read_b128 a[44:47], v3 offset:41600
  v_mfma_f32_16x16x32_bf16 v[20:23], a[208:211], a[4:7], v[48:51]
  ds_read_b128 a[48:51], v2 offset:14016
  ds_read_b128 a[52:55], v2 offset:41664
  v_mfma_f32_16x16x32_bf16 v[244:247], v[188:191], a[0:3], v[52:55]
  ds_read_b128 a[56:59], v3 offset:14016
  ds_read_b128 a[60:63], v3 offset:41664
  v_mfma_f32_16x16x32_bf16 v[24:27], a[208:211], a[8:11], v[48:51]
  ds_read_b128 a[64:67], v2 offset:14080
  ds_read_b128 a[68:71], v2 offset:41728
  v_mfma_f32_16x16x32_bf16 v[248:251], v[188:191], a[4:7], v[52:55]
  buffer_load_dwordx4 v[188:191], v7, s[24:27], s64 offen
  ds_read_b128 a[72:75], v3 offset:14080
  v_mfma_f32_16x16x32_bf16 v[28:31], a[208:211], a[12:15], v[48:51]
  buffer_load_dwordx4 a[208:211], v241, s[24:27], s64 offen
  s_waitcnt lgkmcnt(11)
  v_mfma_f32_16x16x32_bf16 v[16:19], a[212:215], a[16:19], v[16:19]
  ds_read_b128 a[76:79], v3 offset:41728
  ds_read_b128 a[80:83], v2 offset:14144
  v_mfma_f32_16x16x32_bf16 v[20:23], a[212:215], a[20:23], v[20:23]
  ds_read_b128 a[84:87], v2 offset:41792
  ds_read_b128 a[88:91], v3 offset:14144
  v_mfma_f32_16x16x32_bf16 v[244:247], v[192:195], a[16:19], v[244:247]
  ds_read_b128 a[92:95], v3 offset:41792
  ds_read_b128 a[96:99], v2 offset:14208
  v_mfma_f32_16x16x32_bf16 v[24:27], a[212:215], a[24:27], v[24:27]
  ds_read_b128 a[100:103], v2 offset:41856
  ds_read_b128 a[104:107], v3 offset:14208
  v_mfma_f32_16x16x32_bf16 v[248:251], v[192:195], a[20:23], v[248:251]
  buffer_load_dwordx4 v[192:195], v7, s[24:27], s65 offen
  ds_read_b128 a[108:111], v3 offset:41856
  v_mfma_f32_16x16x32_bf16 v[28:31], a[212:215], a[28:31], v[28:31]
  buffer_load_dwordx4 a[212:215], v241, s[24:27], s65 offen
  s_waitcnt vmcnt(13) lgkmcnt(15)
  v_mfma_f32_16x16x32_bf16 v[16:19], a[216:219], a[32:35], v[16:19]
  ds_read_b128 a[112:115], v2 offset:14272
  ds_read_b128 a[116:119], v2 offset:41920
  v_mfma_f32_16x16x32_bf16 v[20:23], a[216:219], a[36:39], v[20:23]
  ds_read_b128 a[120:123], v3 offset:14272
  ds_read_b128 a[124:127], v3 offset:41920
  v_mfma_f32_16x16x32_bf16 v[244:247], v[196:199], a[32:35], v[244:247]
  ds_read_b128 a[128:131], v2 offset:14336
  ds_read_b128 a[132:135], v2 offset:41984
  v_mfma_f32_16x16x32_bf16 v[24:27], a[216:219], a[40:43], v[24:27]
  ds_read_b128 a[136:139], v3 offset:14336
  ds_read_b128 a[140:143], v3 offset:41984
  v_mfma_f32_16x16x32_bf16 v[248:251], v[196:199], a[36:39], v[248:251]
  buffer_load_dwordx4 v[196:199], v7, s[24:27], s66 offen
  ds_read_b128 a[144:147], v2 offset:14400
  v_mfma_f32_16x16x32_bf16 v[28:31], a[216:219], a[44:47], v[28:31]
  buffer_load_dwordx4 a[216:219], v241, s[24:27], s66 offen
  s_waitcnt lgkmcnt(15)
  v_mfma_f32_16x16x32_bf16 v[16:19], a[220:223], a[48:51], v[16:19]
  ds_read_b128 a[148:151], v2 offset:42048
  ds_read_b128 a[152:155], v3 offset:14400
  v_mfma_f32_16x16x32_bf16 v[20:23], a[220:223], a[52:55], v[20:23]
  ds_read_b128 a[156:159], v3 offset:42048
  ds_read_b128 a[160:163], v2 offset:14464
  v_mfma_f32_16x16x32_bf16 v[244:247], v[200:203], a[48:51], v[244:247]
  ds_read_b128 a[164:167], v2 offset:42112
  ds_read_b128 a[168:171], v3 offset:14464
  v_mfma_f32_16x16x32_bf16 v[24:27], a[220:223], a[56:59], v[24:27]
  ds_read_b128 a[172:175], v3 offset:42112
  ds_read_b128 a[176:179], v2 offset:14528
  v_mfma_f32_16x16x32_bf16 v[248:251], v[200:203], a[52:55], v[248:251]
  buffer_load_dwordx4 v[200:203], v7, s[24:27], s67 offen
  ds_read_b128 a[180:183], v2 offset:42176
  v_mfma_f32_16x16x32_bf16 v[28:31], a[220:223], a[60:63], v[28:31]
  buffer_load_dwordx4 a[220:223], v241, s[24:27], s67 offen
  s_waitcnt vmcnt(15)
  v_mfma_f32_16x16x32_bf16 v[16:19], a[224:227], a[64:67], v[16:19]
  ds_read_b128 a[184:187], v3 offset:14528
  ds_read_b128 a[188:191], v3 offset:42176
  v_mfma_f32_16x16x32_bf16 v[20:23], a[224:227], a[68:71], v[20:23]
  ds_read_b128 a[192:195], v2 offset:14592
  ds_read_b128 a[196:199], v2 offset:42240
  v_mfma_f32_16x16x32_bf16 v[244:247], v[204:207], a[64:67], v[244:247]
  ds_read_b128 a[200:203], v3 offset:14592
  ds_read_b128 a[204:207], v3 offset:42240
  v_mfma_f32_16x16x32_bf16 v[24:27], a[224:227], a[72:75], v[24:27]
  v_add_u32 v10, s84, v4
  ds_read_b64 v[64:65], v10 offset:13824
  v_mfma_f32_16x16x32_bf16 v[248:251], v[204:207], a[68:71], v[248:251]
  buffer_load_dwordx4 v[204:207], v7, s[24:27], s68 offen
  ds_read_b64 v[66:67], v10 offset:41472
  v_mfma_f32_16x16x32_bf16 v[28:31], a[224:227], a[76:79], v[28:31]
  buffer_load_dwordx4 a[224:227], v241, s[24:27], s68 offen
  s_waitcnt lgkmcnt(15)
  v_mfma_f32_16x16x32_bf16 v[16:19], a[228:231], a[80:83], v[16:19]
  v_add_u32 v8, s85, v4
  v_add_u32 v9, s85, v5
  v_mfma_f32_16x16x32_bf16 v[20:23], a[228:231], a[84:87], v[20:23]
  ds_read_b64 v[56:57], v8 offset:13824
  ds_read_b64 v[58:59], v8 offset:41472
  v_mfma_f32_16x16x32_bf16 v[244:247], v[208:211], a[80:83], v[244:247]
  ds_read_b64 v[60:61], v9 offset:13824
  ds_read_b64 v[62:63], v9 offset:41472
  v_mfma_f32_16x16x32_bf16 v[24:27], a[228:231], a[88:91], v[24:27]
  v_add_u32 v240, s93, v6
  ds_read_b128 v[52:55], v240 offset:1664
  v_mfma_f32_16x16x32_bf16 v[248:251], v[208:211], a[84:87], v[248:251]
  buffer_load_dwordx4 v[208:211], v7, s[24:27], s69 offen
  v_mfma_f32_16x16x32_bf16 v[28:31], a[228:231], a[92:95], v[28:31]
  buffer_load_dwordx4 a[228:231], v241, s[24:27], s69 offen
  s_waitcnt vmcnt(17)
  v_mfma_f32_16x16x32_bf16 v[16:19], a[232:235], a[96:99], v[16:19]
  v_mfma_f32_16x16x32_bf16 v[20:23], a[232:235], a[100:103], v[20:23]
  v_mfma_f32_16x16x32_bf16 v[244:247], v[212:215], a[96:99], v[244:247]
  v_mfma_f32_16x16x32_bf16 v[24:27], a[232:235], a[104:107], v[24:27]
  v_mfma_f32_16x16x32_bf16 v[248:251], v[212:215], a[100:103], v[248:251]
  buffer_load_dwordx4 v[212:215], v7, s[24:27], s70 offen
  v_mfma_f32_16x16x32_bf16 v[28:31], a[232:235], a[108:111], v[28:31]
  buffer_load_dwordx4 a[232:235], v241, s[24:27], s70 offen
  v_mfma_f32_16x16x32_bf16 v[16:19], a[236:239], a[112:115], v[16:19]
  v_mfma_f32_16x16x32_bf16 v[20:23], a[236:239], a[116:119], v[20:23]
  v_mfma_f32_16x16x32_bf16 v[244:247], v[216:219], a[112:115], v[244:247]
  v_mfma_f32_16x16x32_bf16 v[24:27], a[236:239], a[120:123], v[24:27]
  v_mfma_f32_16x16x32_bf16 v[248:251], v[216:219], a[116:119], v[248:251]
  buffer_load_dwordx4 v[216:219], v7, s[24:27], s71 offen
  v_mfma_f32_16x16x32_bf16 v[28:31], a[236:239], a[124:127], v[28:31]
  buffer_load_dwordx4 a[236:239], v241, s[24:27], s71 offen
  s_waitcnt vmcnt(19)
  v_mfma_f32_16x16x32_bf16 v[16:19], a[240:243], a[128:131], v[16:19]
  v_mfma_f32_16x16x32_bf16 v[20:23], a[240:243], a[132:135], v[20:23]
  v_mfma_f32_16x16x32_bf16 v[244:247], v[220:223], a[128:131], v[244:247]
  v_mfma_f32_16x16x32_bf16 v[24:27], a[240:243], a[136:139], v[24:27]
  v_mfma_f32_16x16x32_bf16 v[248:251], v[220:223], a[132:135], v[248:251]
  buffer_load_dwordx4 v[220:223], v7, s[24:27], s72 offen
  v_mfma_f32_16x16x32_bf16 v[28:31], a[240:243], a[140:143], v[28:31]
  buffer_load_dwordx4 a[240:243], v241, s[24:27], s72 offen
  s_waitcnt lgkmcnt(15)
  v_mfma_f32_16x16x32_bf16 v[16:19], a[244:247], a[144:147], v[16:19]
  v_mfma_f32_16x16x32_bf16 v[20:23], a[244:247], a[148:151], v[20:23]
  v_mfma_f32_16x16x32_bf16 v[244:247], v[224:227], a[144:147], v[244:247]
  v_mfma_f32_16x16x32_bf16 v[24:27], a[244:247], a[152:155], v[24:27]
  v_mfma_f32_16x16x32_bf16 v[248:251], v[224:227], a[148:151], v[248:251]
  buffer_load_dwordx4 v[224:227], v7, s[24:27], s73 offen
  v_mfma_f32_16x16x32_bf16 v[28:31], a[244:247], a[156:159], v[28:31]
  buffer_load_dwordx4 a[244:247], v241, s[24:27], s73 offen
  s_waitcnt vmcnt(21)
  v_mfma_f32_16x16x32_bf16 v[16:19], a[248:251], a[160:163], v[16:19]
  v_mfma_f32_16x16x32_bf16 v[20:23], a[248:251], a[164:167], v[20:23]
  v_mfma_f32_16x16x32_bf16 v[244:247], v[228:231], a[160:163], v[244:247]
  v_mfma_f32_16x16x32_bf16 v[24:27], a[248:251], a[168:171], v[24:27]
  v_mfma_f32_16x16x32_bf16 v[248:251], v[228:231], a[164:167], v[248:251]
  buffer_load_dwordx4 v[228:231], v7, s[24:27], s74 offen
  v_mfma_f32_16x16x32_bf16 v[28:31], a[248:251], a[172:175], v[28:31]
  buffer_load_dwordx4 a[248:251], v241, s[24:27], s74 offen
  s_waitcnt lgkmcnt(11)
  v_mfma_f32_16x16x32_bf16 v[16:19], a[252:255], a[176:179], v[16:19]
  v_mfma_f32_16x16x32_bf16 v[20:23], a[252:255], a[180:183], v[20:23]
  v_mfma_f32_16x16x32_bf16 v[244:247], v[232:235], a[176:179], v[244:247]
  v_mfma_f32_16x16x32_bf16 v[24:27], a[252:255], a[184:187], v[24:27]
  v_mfma_f32_16x16x32_bf16 v[248:251], v[232:235], a[180:183], v[248:251]
  buffer_load_dwordx4 v[232:235], v7, s[24:27], s75 offen
  v_mfma_f32_16x16x32_bf16 v[28:31], a[252:255], a[188:191], v[28:31]
  buffer_load_dwordx4 a[252:255], v241, s[24:27], s75 offen
  s_waitcnt vmcnt(24) lgkmcnt(7)
  v_mfma_f32_16x16x32_bf16 v[16:19], v[184:187], a[192:195], v[16:19]
  v_mfma_f32_16x16x32_bf16 v[20:23], v[184:187], a[196:199], v[20:23]
  v_mfma_f32_16x16x32_bf16 v[244:247], v[236:239], a[192:195], v[244:247]
  v_mfma_f32_16x16x32_bf16 v[24:27], v[184:187], a[200:203], v[24:27]
  v_mfma_f32_16x16x32_bf16 v[248:251], v[236:239], a[196:199], v[248:251]
  buffer_load_dwordx4 v[236:239], v7, s[24:27], s76 offen
  v_mfma_f32_16x16x32_bf16 v[28:31], v[184:187], a[204:207], v[28:31]
  buffer_load_dwordx4 v[184:187], v241, s[24:27], s76 offen
  s_add_u32 s33, s34, s81
  v_add_u32 v7, s33, v1
  s_waitcnt vmcnt(23) lgkmcnt(0)
  v_mfma_f32_16x16x32_bf16 v[32:35], v[188:191], a[0:3], v[52:55]
  v_mfma_f32_16x16x32_bf16 v[36:39], v[188:191], a[4:7], v[52:55]
  v_mfma_f32_16x16x32_bf16 v[40:43], v[188:191], a[8:11], v[52:55]
  v_mfma_f32_16x16x32_bf16 v[44:47], v[188:191], a[12:15], v[52:55]
  buffer_load_dwordx4 v[188:191], v7, s[24:27], s64 offen
  v_mfma_f32_16x16x32_bf16 v[32:35], v[192:195], a[16:19], v[32:35]
  v_lshlrev_b32 v72, 16, v64
  v_and_b32 v73, s50, v64
  v_mfma_f32_16x16x32_bf16 v[36:39], v[192:195], a[20:23], v[36:39]
  v_lshlrev_b32 v74, 16, v65
  v_and_b32 v75, s50, v65
  v_mfma_f32_16x16x32_bf16 v[40:43], v[192:195], a[24:27], v[40:43]
  v_fma_f32 v244, v80, v244, v72
  v_fma_f32 v245, v81, v245, v73
  v_mfma_f32_16x16x32_bf16 v[44:47], v[192:195], a[28:31], v[44:47]
  buffer_load_dwordx4 v[192:195], v7, s[24:27], s65 offen
  s_waitcnt vmcnt(21)
  v_mfma_f32_16x16x32_bf16 v[32:35], v[196:199], a[32:35], v[32:35]
  v_fma_f32 v246, v82, v246, v74
  v_fma_f32 v247, v83, v247, v75
  v_mfma_f32_16x16x32_bf16 v[36:39], v[196:199], a[36:39], v[36:39]
  v_cvt_pk_bf16_f32 v64, v244, v245
  v_cvt_pk_bf16_f32 v65, v246, v247
  v_mfma_f32_16x16x32_bf16 v[40:43], v[196:199], a[40:43], v[40:43]
  ds_write_b64 v10, v[64:65] offset:0
  v_lshlrev_b32 v76, 16, v66
  v_mfma_f32_16x16x32_bf16 v[44:47], v[196:199], a[44:47], v[44:47]
  buffer_load_dwordx4 v[196:199], v7, s[24:27], s66 offen
  v_and_b32 v77, s50, v66
  v_mfma_f32_16x16x32_bf16 v[32:35], v[200:203], a[48:51], v[32:35]
  v_lshlrev_b32 v78, 16, v67
  v_and_b32 v79, s50, v67
  v_mfma_f32_16x16x32_bf16 v[36:39], v[200:203], a[52:55], v[36:39]
  v_fma_f32 v248, v84, v248, v76
  v_fma_f32 v249, v85, v249, v77
  v_mfma_f32_16x16x32_bf16 v[40:43], v[200:203], a[56:59], v[40:43]
  v_fma_f32 v250, v86, v250, v78
  v_fma_f32 v251, v87, v251, v79
  v_mfma_f32_16x16x32_bf16 v[44:47], v[200:203], a[60:63], v[44:47]
  buffer_load_dwordx4 v[200:203], v7, s[24:27], s67 offen
  s_waitcnt vmcnt(19)
  v_mfma_f32_16x16x32_bf16 v[32:35], v[204:207], a[64:67], v[32:35]
  v_cvt_pk_bf16_f32 v66, v248, v249
  v_cvt_pk_bf16_f32 v67, v250, v251
  v_mfma_f32_16x16x32_bf16 v[36:39], v[204:207], a[68:71], v[36:39]
  ds_write_b64 v10, v[66:67] offset:27648
  v_lshlrev_b32 v72, 16, v56
  v_mfma_f32_16x16x32_bf16 v[40:43], v[204:207], a[72:75], v[40:43]
  v_and_b32 v73, s50, v56
  v_lshlrev_b32 v74, 16, v57
  v_mfma_f32_16x16x32_bf16 v[44:47], v[204:207], a[76:79], v[44:47]
  buffer_load_dwordx4 v[204:207], v7, s[24:27], s68 offen
  v_and_b32 v75, s50, v57
  v_mfma_f32_16x16x32_bf16 v[32:35], v[208:211], a[80:83], v[32:35]
  v_fma_f32 v16, v88, v16, v72
  v_fma_f32 v17, v89, v17, v73
  v_mfma_f32_16x16x32_bf16 v[36:39], v[208:211], a[84:87], v[36:39]
  v_fma_f32 v18, v90, v18, v74
  v_fma_f32 v19, v91, v19, v75
  v_mfma_f32_16x16x32_bf16 v[40:43], v[208:211], a[88:91], v[40:43]
  v_cvt_pk_bf16_f32 v56, v16, v17
  v_cvt_pk_bf16_f32 v57, v18, v19
  v_mfma_f32_16x16x32_bf16 v[44:47], v[208:211], a[92:95], v[44:47]
  buffer_load_dwordx4 v[208:211], v7, s[24:27], s69 offen
  s_waitcnt vmcnt(17)
  v_mfma_f32_16x16x32_bf16 v[32:35], v[212:215], a[96:99], v[32:35]
  ds_write_b64 v8, v[56:57] offset:0
  v_lshlrev_b32 v76, 16, v58
  v_mfma_f32_16x16x32_bf16 v[36:39], v[212:215], a[100:103], v[36:39]
  v_and_b32 v77, s50, v58
  v_lshlrev_b32 v78, 16, v59
  v_mfma_f32_16x16x32_bf16 v[40:43], v[212:215], a[104:107], v[40:43]
  v_and_b32 v79, s50, v59
  v_fma_f32 v20, v92, v20, v76
  v_mfma_f32_16x16x32_bf16 v[44:47], v[212:215], a[108:111], v[44:47]
  buffer_load_dwordx4 v[212:215], v7, s[24:27], s70 offen
  v_fma_f32 v21, v93, v21, v77
  v_mfma_f32_16x16x32_bf16 v[32:35], v[216:219], a[112:115], v[32:35]
  v_fma_f32 v22, v94, v22, v78
  v_fma_f32 v23, v95, v23, v79
  v_mfma_f32_16x16x32_bf16 v[36:39], v[216:219], a[116:119], v[36:39]
  v_cvt_pk_bf16_f32 v58, v20, v21
  v_cvt_pk_bf16_f32 v59, v22, v23
  v_mfma_f32_16x16x32_bf16 v[40:43], v[216:219], a[120:123], v[40:43]
  ds_write_b64 v8, v[58:59] offset:27648
  v_lshlrev_b32 v72, 16, v60
  v_mfma_f32_16x16x32_bf16 v[44:47], v[216:219], a[124:127], v[44:47]
  buffer_load_dwordx4 v[216:219], v7, s[24:27], s71 offen
  s_waitcnt vmcnt(15)
  v_mfma_f32_16x16x32_bf16 v[32:35], v[220:223], a[128:131], v[32:35]
  v_and_b32 v73, s50, v60
  v_lshlrev_b32 v74, 16, v61
  v_mfma_f32_16x16x32_bf16 v[36:39], v[220:223], a[132:135], v[36:39]
  v_and_b32 v75, s50, v61
  v_fma_f32 v24, v96, v24, v72
  v_mfma_f32_16x16x32_bf16 v[40:43], v[220:223], a[136:139], v[40:43]
  v_fma_f32 v25, v97, v25, v73
  v_fma_f32 v26, v98, v26, v74
  v_mfma_f32_16x16x32_bf16 v[44:47], v[220:223], a[140:143], v[44:47]
  buffer_load_dwordx4 v[220:223], v7, s[24:27], s72 offen
  v_fma_f32 v27, v99, v27, v75
  v_mfma_f32_16x16x32_bf16 v[32:35], v[224:227], a[144:147], v[32:35]
  v_cvt_pk_bf16_f32 v60, v24, v25
  v_cvt_pk_bf16_f32 v61, v26, v27
  v_mfma_f32_16x16x32_bf16 v[36:39], v[224:227], a[148:151], v[36:39]
  ds_write_b64 v9, v[60:61] offset:0
  v_lshlrev_b32 v76, 16, v62
  v_mfma_f32_16x16x32_bf16 v[40:43], v[224:227], a[152:155], v[40:43]
  v_and_b32 v77, s50, v62
  v_lshlrev_b32 v78, 16, v63
  v_mfma_f32_16x16x32_bf16 v[44:47], v[224:227], a[156:159], v[44:47]
  buffer_load_dwordx4 v[224:227], v7, s[24:27], s73 offen
  s_waitcnt vmcnt(13)
  v_mfma_f32_16x16x32_bf16 v[32:35], v[228:231], a[160:163], v[32:35]
  v_and_b32 v79, s50, v63
  v_fma_f32 v28, v100, v28, v76
  v_mfma_f32_16x16x32_bf16 v[36:39], v[228:231], a[164:167], v[36:39]
  v_fma_f32 v29, v101, v29, v77
  v_fma_f32 v30, v102, v30, v78
  v_mfma_f32_16x16x32_bf16 v[40:43], v[228:231], a[168:171], v[40:43]
  v_fma_f32 v31, v103, v31, v79
  v_cvt_pk_bf16_f32 v62, v28, v29
  v_mfma_f32_16x16x32_bf16 v[44:47], v[228:231], a[172:175], v[44:47]
  buffer_load_dwordx4 v[228:231], v7, s[24:27], s74 offen
  v_cvt_pk_bf16_f32 v63, v30, v31
  v_mfma_f32_16x16x32_bf16 v[32:35], v[232:235], a[176:179], v[32:35]
  ds_write_b64 v9, v[62:63] offset:27648
  v_add_u32 v10, s86, v4
  v_mfma_f32_16x16x32_bf16 v[36:39], v[232:235], a[180:183], v[36:39]
  v_add_u32 v11, s86, v5
  ds_read_b64 v[64:65], v10 offset:13824
  v_mfma_f32_16x16x32_bf16 v[40:43], v[232:235], a[184:187], v[40:43]
  ds_read_b64 v[66:67], v10 offset:41472
  ds_read_b64 v[68:69], v11 offset:13824
  v_mfma_f32_16x16x32_bf16 v[44:47], v[232:235], a[188:191], v[44:47]
  buffer_load_dwordx4 v[232:235], v7, s[24:27], s75 offen
  s_waitcnt vmcnt(13)
  v_mfma_f32_16x16x32_bf16 v[32:35], v[236:239], a[192:195], v[32:35]
  ds_read_b64 v[70:71], v11 offset:41472
  v_add_u32 v240, s94, v6
  v_mfma_f32_16x16x32_bf16 v[36:39], v[236:239], a[196:199], v[36:39]
  ds_read_b128 v[48:51], v240 offset:1664
  v_mfma_f32_16x16x32_bf16 v[40:43], v[236:239], a[200:203], v[40:43]
  v_mfma_f32_16x16x32_bf16 v[44:47], v[236:239], a[204:207], v[44:47]
  buffer_load_dwordx4 v[236:239], v7, s[24:27], s76 offen
  s_add_u32 s33, s34, s82
  v_add_u32 v7, s33, v1
  s_waitcnt lgkmcnt(0)
  v_mfma_f32_16x16x32_bf16 v[16:19], a[208:211], a[0:3], v[48:51]
  v_mfma_f32_16x16x32_bf16 v[20:23], a[208:211], a[4:7], v[48:51]
  v_mfma_f32_16x16x32_bf16 v[24:27], a[208:211], a[8:11], v[48:51]
  v_mfma_f32_16x16x32_bf16 v[28:31], a[208:211], a[12:15], v[48:51]
  buffer_load_dwordx4 a[208:211], v7, s[24:27], s64 offen
  v_mfma_f32_16x16x32_bf16 v[16:19], a[212:215], a[16:19], v[16:19]
  v_lshlrev_b32 v72, 16, v64
  v_and_b32 v73, s50, v64
  v_mfma_f32_16x16x32_bf16 v[20:23], a[212:215], a[20:23], v[20:23]
  v_lshlrev_b32 v74, 16, v65
  v_and_b32 v75, s50, v65
  v_mfma_f32_16x16x32_bf16 v[24:27], a[212:215], a[24:27], v[24:27]
  v_fma_f32 v32, v104, v32, v72
  v_fma_f32 v33, v105, v33, v73
  v_mfma_f32_16x16x32_bf16 v[28:31], a[212:215], a[28:31], v[28:31]
  buffer_load_dwordx4 a[212:215], v7, s[24:27], s65 offen
  v_mfma_f32_16x16x32_bf16 v[16:19], a[216:219], a[32:35], v[16:19]
  v_fma_f32 v34, v106, v34, v74
  v_fma_f32 v35, v107, v35, v75
  v_mfma_f32_16x16x32_bf16 v[20:23], a[216:219], a[36:39], v[20:23]
  v_cvt_pk_bf16_f32 v64, v32, v33
  v_cvt_pk_bf16_f32 v65, v34, v35
  v_mfma_f32_16x16x32_bf16 v[24:27], a[216:219], a[40:43], v[24:27]
  ds_write_b64 v10, v[64:65] offset:0
  v_lshlrev_b32 v76, 16, v66
  v_mfma_f32_16x16x32_bf16 v[28:31], a[216:219], a[44:47], v[28:31]
  buffer_load_dwordx4 a[216:219], v7, s[24:27], s66 offen
  v_and_b32 v77, s50, v66
  v_mfma_f32_16x16x32_bf16 v[16:19], a[220:223], a[48:51], v[16:19]
  v_lshlrev_b32 v78, 16, v67
  v_and_b32 v79, s50, v67
  v_mfma_f32_16x16x32_bf16 v[20:23], a[220:223], a[52:55], v[20:23]
  v_fma_f32 v36, v108, v36, v76
  v_fma_f32 v37, v109, v37, v77
  v_mfma_f32_16x16x32_bf16 v[24:27], a[220:223], a[56:59], v[24:27]
  v_fma_f32 v38, v110, v38, v78
  v_fma_f32 v39, v111, v39, v79
  v_mfma_f32_16x16x32_bf16 v[28:31], a[220:223], a[60:63], v[28:31]
  buffer_load_dwordx4 a[220:223], v7, s[24:27], s67 offen
  v_mfma_f32_16x16x32_bf16 v[16:19], a[224:227], a[64:67], v[16:19]
  v_cvt_pk_bf16_f32 v66, v36, v37
  v_cvt_pk_bf16_f32 v67, v38, v39
  v_mfma_f32_16x16x32_bf16 v[20:23], a[224:227], a[68:71], v[20:23]
  ds_write_b64 v10, v[66:67] offset:27648
  v_lshlrev_b32 v72, 16, v68
  v_mfma_f32_16x16x32_bf16 v[24:27], a[224:227], a[72:75], v[24:27]
  v_and_b32 v73, s50, v68
  v_lshlrev_b32 v74, 16, v69
  v_mfma_f32_16x16x32_bf16 v[28:31], a[224:227], a[76:79], v[28:31]
  buffer_load_dwordx4 a[224:227], v7, s[24:27], s68 offen
  v_and_b32 v75, s50, v69
  v_mfma_f32_16x16x32_bf16 v[16:19], a[228:231], a[80:83], v[16:19]
  v_fma_f32 v40, v112, v40, v72
  v_fma_f32 v41, v113, v41, v73
  v_mfma_f32_16x16x32_bf16 v[20:23], a[228:231], a[84:87], v[20:23]
  v_fma_f32 v42, v114, v42, v74
  v_fma_f32 v43, v115, v43, v75
  v_mfma_f32_16x16x32_bf16 v[24:27], a[228:231], a[88:91], v[24:27]
  v_cvt_pk_bf16_f32 v68, v40, v41
  v_cvt_pk_bf16_f32 v69, v42, v43
  v_mfma_f32_16x16x32_bf16 v[28:31], a[228:231], a[92:95], v[28:31]
  buffer_load_dwordx4 a[228:231], v7, s[24:27], s69 offen
  v_mfma_f32_16x16x32_bf16 v[16:19], a[232:235], a[96:99], v[16:19]
  ds_write_b64 v11, v[68:69] offset:0
  v_lshlrev_b32 v76, 16, v70
  v_mfma_f32_16x16x32_bf16 v[20:23], a[232:235], a[100:103], v[20:23]
  v_and_b32 v77, s50, v70
  v_lshlrev_b32 v78, 16, v71
  v_mfma_f32_16x16x32_bf16 v[24:27], a[232:235], a[104:107], v[24:27]
  v_and_b32 v79, s50, v71
  v_fma_f32 v44, v116, v44, v76
  v_mfma_f32_16x16x32_bf16 v[28:31], a[232:235], a[108:111], v[28:31]
  buffer_load_dwordx4 a[232:235], v7, s[24:27], s70 offen
  v_fma_f32 v45, v117, v45, v77
  v_mfma_f32_16x16x32_bf16 v[16:19], a[236:239], a[112:115], v[16:19]
  v_fma_f32 v46, v118, v46, v78
  v_fma_f32 v47, v119, v47, v79
  v_mfma_f32_16x16x32_bf16 v[20:23], a[236:239], a[116:119], v[20:23]
  v_cvt_pk_bf16_f32 v70, v44, v45
  v_cvt_pk_bf16_f32 v71, v46, v47
  v_mfma_f32_16x16x32_bf16 v[24:27], a[236:239], a[120:123], v[24:27]
  ds_write_b64 v11, v[70:71] offset:27648
  v_add_u32 v8, s87, v4
  v_mfma_f32_16x16x32_bf16 v[28:31], a[236:239], a[124:127], v[28:31]
  buffer_load_dwordx4 a[236:239], v7, s[24:27], s71 offen
  v_mfma_f32_16x16x32_bf16 v[16:19], a[240:243], a[128:131], v[16:19]
  v_add_u32 v9, s87, v5
  ds_read_b64 v[56:57], v8 offset:13824
  v_mfma_f32_16x16x32_bf16 v[20:23], a[240:243], a[132:135], v[20:23]
  ds_read_b64 v[58:59], v8 offset:41472
  ds_read_b64 v[60:61], v9 offset:13824
  v_mfma_f32_16x16x32_bf16 v[24:27], a[240:243], a[136:139], v[24:27]
  ds_read_b64 v[62:63], v9 offset:41472
  v_add_u32 v240, s95, v6
  v_mfma_f32_16x16x32_bf16 v[28:31], a[240:243], a[140:143], v[28:31]
  buffer_load_dwordx4 a[240:243], v7, s[24:27], s72 offen
  ds_read_b128 v[52:55], v240 offset:1664
  v_mfma_f32_16x16x32_bf16 v[16:19], a[244:247], a[144:147], v[16:19]
  v_mfma_f32_16x16x32_bf16 v[20:23], a[244:247], a[148:151], v[20:23]
  v_mfma_f32_16x16x32_bf16 v[24:27], a[244:247], a[152:155], v[24:27]
  v_mfma_f32_16x16x32_bf16 v[28:31], a[244:247], a[156:159], v[28:31]
  buffer_load_dwordx4 a[244:247], v7, s[24:27], s73 offen
  v_mfma_f32_16x16x32_bf16 v[16:19], a[248:251], a[160:163], v[16:19]
  v_mfma_f32_16x16x32_bf16 v[20:23], a[248:251], a[164:167], v[20:23]
  v_mfma_f32_16x16x32_bf16 v[24:27], a[248:251], a[168:171], v[24:27]
  v_mfma_f32_16x16x32_bf16 v[28:31], a[248:251], a[172:175], v[28:31]
  buffer_load_dwordx4 a[248:251], v7, s[24:27], s74 offen
  v_mfma_f32_16x16x32_bf16 v[16:19], a[252:255], a[176:179], v[16:19]
  v_mfma_f32_16x16x32_bf16 v[20:23], a[252:255], a[180:183], v[20:23]
  v_mfma_f32_16x16x32_bf16 v[24:27], a[252:255], a[184:187], v[24:27]
  v_mfma_f32_16x16x32_bf16 v[28:31], a[252:255], a[188:191], v[28:31]
  buffer_load_dwordx4 a[252:255], v7, s[24:27], s75 offen
  s_waitcnt vmcnt(25)
  v_mfma_f32_16x16x32_bf16 v[16:19], v[184:187], a[192:195], v[16:19]
  v_mfma_f32_16x16x32_bf16 v[20:23], v[184:187], a[196:199], v[20:23]
  v_mfma_f32_16x16x32_bf16 v[24:27], v[184:187], a[200:203], v[24:27]
  v_mfma_f32_16x16x32_bf16 v[28:31], v[184:187], a[204:207], v[28:31]
  buffer_load_dwordx4 v[184:187], v7, s[24:27], s76 offen
  s_add_u32 s33, s34, s83
  v_add_u32 v7, s33, v1
  s_waitcnt vmcnt(24) lgkmcnt(0)
  v_mfma_f32_16x16x32_bf16 v[32:35], v[188:191], a[0:3], v[52:55]
  v_mfma_f32_16x16x32_bf16 v[36:39], v[188:191], a[4:7], v[52:55]
  v_mfma_f32_16x16x32_bf16 v[40:43], v[188:191], a[8:11], v[52:55]
  v_mfma_f32_16x16x32_bf16 v[44:47], v[188:191], a[12:15], v[52:55]
  buffer_load_dwordx4 v[188:191], v7, s[24:27], s64 offen
  v_mfma_f32_16x16x32_bf16 v[32:35], v[192:195], a[16:19], v[32:35]
  v_lshlrev_b32 v72, 16, v56
  v_and_b32 v73, s50, v56
  v_mfma_f32_16x16x32_bf16 v[36:39], v[192:195], a[20:23], v[36:39]
  v_lshlrev_b32 v74, 16, v57
  v_and_b32 v75, s50, v57
  v_mfma_f32_16x16x32_bf16 v[40:43], v[192:195], a[24:27], v[40:43]
  v_fma_f32 v16, v120, v16, v72
  v_fma_f32 v17, v121, v17, v73
  v_mfma_f32_16x16x32_bf16 v[44:47], v[192:195], a[28:31], v[44:47]
  buffer_load_dwordx4 v[192:195], v7, s[24:27], s65 offen
  s_waitcnt vmcnt(24)
  v_mfma_f32_16x16x32_bf16 v[32:35], v[196:199], a[32:35], v[32:35]
  v_fma_f32 v18, v122, v18, v74
  v_fma_f32 v19, v123, v19, v75
  v_mfma_f32_16x16x32_bf16 v[36:39], v[196:199], a[36:39], v[36:39]
  v_cvt_pk_bf16_f32 v56, v16, v17
  v_cvt_pk_bf16_f32 v57, v18, v19
  v_mfma_f32_16x16x32_bf16 v[40:43], v[196:199], a[40:43], v[40:43]
  ds_write_b64 v8, v[56:57] offset:0
  v_lshlrev_b32 v76, 16, v58
  v_mfma_f32_16x16x32_bf16 v[44:47], v[196:199], a[44:47], v[44:47]
  buffer_load_dwordx4 v[196:199], v7, s[24:27], s66 offen
  v_and_b32 v77, s50, v58
  v_mfma_f32_16x16x32_bf16 v[32:35], v[200:203], a[48:51], v[32:35]
  v_lshlrev_b32 v78, 16, v59
  v_and_b32 v79, s50, v59
  v_mfma_f32_16x16x32_bf16 v[36:39], v[200:203], a[52:55], v[36:39]
  v_fma_f32 v20, v124, v20, v76
  v_fma_f32 v21, v125, v21, v77
  v_mfma_f32_16x16x32_bf16 v[40:43], v[200:203], a[56:59], v[40:43]
  v_fma_f32 v22, v126, v22, v78
  v_fma_f32 v23, v127, v23, v79
  v_mfma_f32_16x16x32_bf16 v[44:47], v[200:203], a[60:63], v[44:47]
  buffer_load_dwordx4 v[200:203], v7, s[24:27], s67 offen
  s_waitcnt vmcnt(24)
  v_mfma_f32_16x16x32_bf16 v[32:35], v[204:207], a[64:67], v[32:35]
  v_cvt_pk_bf16_f32 v58, v20, v21
  v_cvt_pk_bf16_f32 v59, v22, v23
  v_mfma_f32_16x16x32_bf16 v[36:39], v[204:207], a[68:71], v[36:39]
  ds_write_b64 v8, v[58:59] offset:27648
  v_lshlrev_b32 v72, 16, v60
  v_mfma_f32_16x16x32_bf16 v[40:43], v[204:207], a[72:75], v[40:43]
  v_and_b32 v73, s50, v60
  v_lshlrev_b32 v74, 16, v61
  v_mfma_f32_16x16x32_bf16 v[44:47], v[204:207], a[76:79], v[44:47]
  buffer_load_dwordx4 v[204:207], v7, s[24:27], s68 offen
  v_and_b32 v75, s50, v61
  v_mfma_f32_16x16x32_bf16 v[32:35], v[208:211], a[80:83], v[32:35]
  v_fma_f32 v24, v128, v24, v72
  v_fma_f32 v25, v129, v25, v73
  v_mfma_f32_16x16x32_bf16 v[36:39], v[208:211], a[84:87], v[36:39]
  v_fma_f32 v26, v130, v26, v74
  v_fma_f32 v27, v131, v27, v75
  v_mfma_f32_16x16x32_bf16 v[40:43], v[208:211], a[88:91], v[40:43]
  v_cvt_pk_bf16_f32 v60, v24, v25
  v_cvt_pk_bf16_f32 v61, v26, v27
  v_mfma_f32_16x16x32_bf16 v[44:47], v[208:211], a[92:95], v[44:47]
  buffer_load_dwordx4 v[208:211], v7, s[24:27], s69 offen
  s_waitcnt vmcnt(24)
  v_mfma_f32_16x16x32_bf16 v[32:35], v[212:215], a[96:99], v[32:35]
  ds_write_b64 v9, v[60:61] offset:0
  v_lshlrev_b32 v76, 16, v62
  v_mfma_f32_16x16x32_bf16 v[36:39], v[212:215], a[100:103], v[36:39]
  v_and_b32 v77, s50, v62
  v_lshlrev_b32 v78, 16, v63
  v_mfma_f32_16x16x32_bf16 v[40:43], v[212:215], a[104:107], v[40:43]
  v_and_b32 v79, s50, v63
  v_fma_f32 v28, v132, v28, v76
  v_mfma_f32_16x16x32_bf16 v[44:47], v[212:215], a[108:111], v[44:47]
  buffer_load_dwordx4 v[212:215], v7, s[24:27], s70 offen
  v_fma_f32 v29, v133, v29, v77
  v_mfma_f32_16x16x32_bf16 v[32:35], v[216:219], a[112:115], v[32:35]
  v_fma_f32 v30, v134, v30, v78
  v_fma_f32 v31, v135, v31, v79
  v_mfma_f32_16x16x32_bf16 v[36:39], v[216:219], a[116:119], v[36:39]
  v_cvt_pk_bf16_f32 v62, v28, v29
  v_cvt_pk_bf16_f32 v63, v30, v31
  v_mfma_f32_16x16x32_bf16 v[40:43], v[216:219], a[120:123], v[40:43]
  ds_write_b64 v9, v[62:63] offset:27648
  v_add_u32 v10, s88, v4
  v_mfma_f32_16x16x32_bf16 v[44:47], v[216:219], a[124:127], v[44:47]
  buffer_load_dwordx4 v[216:219], v7, s[24:27], s71 offen
  s_waitcnt vmcnt(24)
  v_mfma_f32_16x16x32_bf16 v[32:35], v[220:223], a[128:131], v[32:35]
  v_add_u32 v11, s88, v5
  ds_read_b64 v[64:65], v10 offset:13824
  v_mfma_f32_16x16x32_bf16 v[36:39], v[220:223], a[132:135], v[36:39]
  ds_read_b64 v[66:67], v10 offset:41472
  ds_read_b64 v[68:69], v11 offset:13824
  v_mfma_f32_16x16x32_bf16 v[40:43], v[220:223], a[136:139], v[40:43]
  ds_read_b64 v[70:71], v11 offset:41472
  v_add_u32 v240, s96, v6
  v_mfma_f32_16x16x32_bf16 v[44:47], v[220:223], a[140:143], v[44:47]
  buffer_load_dwordx4 v[220:223], v7, s[24:27], s72 offen
  ds_read_b128 v[48:51], v240 offset:1664
  v_mfma_f32_16x16x32_bf16 v[32:35], v[224:227], a[144:147], v[32:35]
  v_mfma_f32_16x16x32_bf16 v[36:39], v[224:227], a[148:151], v[36:39]
  v_mfma_f32_16x16x32_bf16 v[40:43], v[224:227], a[152:155], v[40:43]
  v_mfma_f32_16x16x32_bf16 v[44:47], v[224:227], a[156:159], v[44:47]
  buffer_load_dwordx4 v[224:227], v7, s[24:27], s73 offen
  s_waitcnt vmcnt(24)
  v_mfma_f32_16x16x32_bf16 v[32:35], v[228:231], a[160:163], v[32:35]
  v_mfma_f32_16x16x32_bf16 v[36:39], v[228:231], a[164:167], v[36:39]
  v_mfma_f32_16x16x32_bf16 v[40:43], v[228:231], a[168:171], v[40:43]
  v_mfma_f32_16x16x32_bf16 v[44:47], v[228:231], a[172:175], v[44:47]
  buffer_load_dwordx4 v[228:231], v7, s[24:27], s74 offen
  v_mfma_f32_16x16x32_bf16 v[32:35], v[232:235], a[176:179], v[32:35]
  v_mfma_f32_16x16x32_bf16 v[36:39], v[232:235], a[180:183], v[36:39]
  v_mfma_f32_16x16x32_bf16 v[40:43], v[232:235], a[184:187], v[40:43]
  v_mfma_f32_16x16x32_bf16 v[44:47], v[232:235], a[188:191], v[44:47]
  buffer_load_dwordx4 v[232:235], v7, s[24:27], s75 offen
  s_waitcnt vmcnt(25)
  v_mfma_f32_16x16x32_bf16 v[32:35], v[236:239], a[192:195], v[32:35]
  v_mfma_f32_16x16x32_bf16 v[36:39], v[236:239], a[196:199], v[36:39]
  v_mfma_f32_16x16x32_bf16 v[40:43], v[236:239], a[200:203], v[40:43]
  v_mfma_f32_16x16x32_bf16 v[44:47], v[236:239], a[204:207], v[44:47]
  buffer_load_dwordx4 v[236:239], v7, s[24:27], s76 offen
  s_add_u32 s34, s34, 346112
  s_add_u32 s33, s34, s77
  v_add_u32 v7, s33, v1
  s_waitcnt vmcnt(24) lgkmcnt(0)
  v_mfma_f32_16x16x32_bf16 v[16:19], a[208:211], a[0:3], v[48:51]
  v_mfma_f32_16x16x32_bf16 v[20:23], a[208:211], a[4:7], v[48:51]
  v_mfma_f32_16x16x32_bf16 v[24:27], a[208:211], a[8:11], v[48:51]
  v_mfma_f32_16x16x32_bf16 v[28:31], a[208:211], a[12:15], v[48:51]
  buffer_load_dwordx4 a[208:211], v7, s[24:27], s64 offen
  v_lshlrev_b32 v72, 16, v64
  v_mfma_f32_16x16x32_bf16 v[16:19], a[212:215], a[16:19], v[16:19]
  v_and_b32 v73, s50, v64
  v_lshlrev_b32 v74, 16, v65
  v_mfma_f32_16x16x32_bf16 v[20:23], a[212:215], a[20:23], v[20:23]
  v_and_b32 v75, s50, v65
  v_fma_f32 v32, v136, v32, v72
  v_mfma_f32_16x16x32_bf16 v[24:27], a[212:215], a[24:27], v[24:27]
  v_fma_f32 v33, v137, v33, v73
  v_fma_f32 v34, v138, v34, v74
  v_mfma_f32_16x16x32_bf16 v[28:31], a[212:215], a[28:31], v[28:31]
  buffer_load_dwordx4 a[212:215], v7, s[24:27], s65 offen
  s_waitcnt vmcnt(24)
  v_mfma_f32_16x16x32_bf16 v[16:19], a[216:219], a[32:35], v[16:19]
  v_fma_f32 v35, v139, v35, v75
  v_cvt_pk_bf16_f32 v64, v32, v33
  v_mfma_f32_16x16x32_bf16 v[20:23], a[216:219], a[36:39], v[20:23]
  v_cvt_pk_bf16_f32 v65, v34, v35
  ds_write_b64 v10, v[64:65] offset:0
  v_mfma_f32_16x16x32_bf16 v[24:27], a[216:219], a[40:43], v[24:27]
  v_lshlrev_b32 v76, 16, v66
  v_and_b32 v77, s50, v66
  v_mfma_f32_16x16x32_bf16 v[28:31], a[216:219], a[44:47], v[28:31]
  buffer_load_dwordx4 a[216:219], v7, s[24:27], s66 offen
  v_lshlrev_b32 v78, 16, v67
  v_mfma_f32_16x16x32_bf16 v[16:19], a[220:223], a[48:51], v[16:19]
  v_and_b32 v79, s50, v67
  v_fma_f32 v36, v140, v36, v76
  v_mfma_f32_16x16x32_bf16 v[20:23], a[220:223], a[52:55], v[20:23]
  v_fma_f32 v37, v141, v37, v77
  v_fma_f32 v38, v142, v38, v78
  v_mfma_f32_16x16x32_bf16 v[24:27], a[220:223], a[56:59], v[24:27]
  v_fma_f32 v39, v143, v39, v79
  v_cvt_pk_bf16_f32 v66, v36, v37
  v_mfma_f32_16x16x32_bf16 v[28:31], a[220:223], a[60:63], v[28:31]
  buffer_load_dwordx4 a[220:223], v7, s[24:27], s67 offen
  s_waitcnt vmcnt(24)
  v_mfma_f32_16x16x32_bf16 v[16:19], a[224:227], a[64:67], v[16:19]
  v_cvt_pk_bf16_f32 v67, v38, v39
  ds_write_b64 v10, v[66:67] offset:27648
  v_mfma_f32_16x16x32_bf16 v[20:23], a[224:227], a[68:71], v[20:23]
  v_lshlrev_b32 v72, 16, v68
  v_and_b32 v73, s50, v68
  v_mfma_f32_16x16x32_bf16 v[24:27], a[224:227], a[72:75], v[24:27]
  v_lshlrev_b32 v74, 16, v69
  v_and_b32 v75, s50, v69
  v_mfma_f32_16x16x32_bf16 v[28:31], a[224:227], a[76:79], v[28:31]
  buffer_load_dwordx4 a[224:227], v7, s[24:27], s68 offen
  v_fma_f32 v40, v144, v40, v72
  v_mfma_f32_16x16x32_bf16 v[16:19], a[228:231], a[80:83], v[16:19]
  v_fma_f32 v41, v145, v41, v73
  v_fma_f32 v42, v146, v42, v74
  v_mfma_f32_16x16x32_bf16 v[20:23], a[228:231], a[84:87], v[20:23]
  v_fma_f32 v43, v147, v43, v75
  v_cvt_pk_bf16_f32 v68, v40, v41
  v_mfma_f32_16x16x32_bf16 v[24:27], a[228:231], a[88:91], v[24:27]
  v_cvt_pk_bf16_f32 v69, v42, v43
  ds_write_b64 v11, v[68:69] offset:0
  v_mfma_f32_16x16x32_bf16 v[28:31], a[228:231], a[92:95], v[28:31]
  buffer_load_dwordx4 a[228:231], v7, s[24:27], s69 offen
  s_waitcnt vmcnt(24)
  v_mfma_f32_16x16x32_bf16 v[16:19], a[232:235], a[96:99], v[16:19]
  v_lshlrev_b32 v76, 16, v70
  v_and_b32 v77, s50, v70
  v_mfma_f32_16x16x32_bf16 v[20:23], a[232:235], a[100:103], v[20:23]
  v_lshlrev_b32 v78, 16, v71
  v_and_b32 v79, s50, v71
  v_mfma_f32_16x16x32_bf16 v[24:27], a[232:235], a[104:107], v[24:27]
  v_fma_f32 v44, v148, v44, v76
  v_fma_f32 v45, v149, v45, v77
  v_mfma_f32_16x16x32_bf16 v[28:31], a[232:235], a[108:111], v[28:31]
  buffer_load_dwordx4 a[232:235], v7, s[24:27], s70 offen
  v_fma_f32 v46, v150, v46, v78
  v_mfma_f32_16x16x32_bf16 v[16:19], a[236:239], a[112:115], v[16:19]
  v_fma_f32 v47, v151, v47, v79
  v_cvt_pk_bf16_f32 v70, v44, v45
  v_mfma_f32_16x16x32_bf16 v[20:23], a[236:239], a[116:119], v[20:23]
  v_cvt_pk_bf16_f32 v71, v46, v47
  ds_write_b64 v11, v[70:71] offset:27648
  v_mfma_f32_16x16x32_bf16 v[24:27], a[236:239], a[120:123], v[24:27]
  v_add_u32 v8, s89, v4
  v_add_u32 v9, s89, v5
  v_mfma_f32_16x16x32_bf16 v[28:31], a[236:239], a[124:127], v[28:31]
  buffer_load_dwordx4 a[236:239], v7, s[24:27], s71 offen
  s_waitcnt vmcnt(24)
  v_mfma_f32_16x16x32_bf16 v[16:19], a[240:243], a[128:131], v[16:19]
  ds_read_b64 v[56:57], v8 offset:13824
  ds_read_b64 v[58:59], v8 offset:41472
  v_mfma_f32_16x16x32_bf16 v[20:23], a[240:243], a[132:135], v[20:23]
  ds_read_b64 v[60:61], v9 offset:13824
  ds_read_b64 v[62:63], v9 offset:41472
  v_mfma_f32_16x16x32_bf16 v[24:27], a[240:243], a[136:139], v[24:27]
  v_add_u32 v240, s97, v6
  ds_read_b128 v[52:55], v240 offset:1664
  v_mfma_f32_16x16x32_bf16 v[28:31], a[240:243], a[140:143], v[28:31]
  buffer_load_dwordx4 a[240:243], v7, s[24:27], s72 offen
  v_mfma_f32_16x16x32_bf16 v[16:19], a[244:247], a[144:147], v[16:19]
  v_mfma_f32_16x16x32_bf16 v[20:23], a[244:247], a[148:151], v[20:23]
  v_mfma_f32_16x16x32_bf16 v[24:27], a[244:247], a[152:155], v[24:27]
  v_mfma_f32_16x16x32_bf16 v[28:31], a[244:247], a[156:159], v[28:31]
  buffer_load_dwordx4 a[244:247], v7, s[24:27], s73 offen
  s_waitcnt vmcnt(24)
  v_mfma_f32_16x16x32_bf16 v[16:19], a[248:251], a[160:163], v[16:19]
  v_mfma_f32_16x16x32_bf16 v[20:23], a[248:251], a[164:167], v[20:23]
  v_mfma_f32_16x16x32_bf16 v[24:27], a[248:251], a[168:171], v[24:27]
  v_mfma_f32_16x16x32_bf16 v[28:31], a[248:251], a[172:175], v[28:31]
  buffer_load_dwordx4 a[248:251], v7, s[24:27], s74 offen
  v_mfma_f32_16x16x32_bf16 v[16:19], a[252:255], a[176:179], v[16:19]
  v_mfma_f32_16x16x32_bf16 v[20:23], a[252:255], a[180:183], v[20:23]
  v_mfma_f32_16x16x32_bf16 v[24:27], a[252:255], a[184:187], v[24:27]
  v_mfma_f32_16x16x32_bf16 v[28:31], a[252:255], a[188:191], v[28:31]
  buffer_load_dwordx4 a[252:255], v7, s[24:27], s75 offen
  s_waitcnt vmcnt(25)
  v_mfma_f32_16x16x32_bf16 v[16:19], v[184:187], a[192:195], v[16:19]
  v_mfma_f32_16x16x32_bf16 v[20:23], v[184:187], a[196:199], v[20:23]
  v_mfma_f32_16x16x32_bf16 v[24:27], v[184:187], a[200:203], v[24:27]
  v_mfma_f32_16x16x32_bf16 v[28:31], v[184:187], a[204:207], v[28:31]
  buffer_load_dwordx4 v[184:187], v7, s[24:27], s76 offen
  s_add_u32 s33, s34, s78
  v_add_u32 v7, s33, v1
  s_waitcnt vmcnt(24) lgkmcnt(0)
  v_mfma_f32_16x16x32_bf16 v[32:35], v[188:191], a[0:3], v[52:55]
  v_mfma_f32_16x16x32_bf16 v[36:39], v[188:191], a[4:7], v[52:55]
  v_mfma_f32_16x16x32_bf16 v[40:43], v[188:191], a[8:11], v[52:55]
  v_mfma_f32_16x16x32_bf16 v[44:47], v[188:191], a[12:15], v[52:55]
  buffer_load_dwordx4 v[188:191], v7, s[24:27], s64 offen
  v_mfma_f32_16x16x32_bf16 v[32:35], v[192:195], a[16:19], v[32:35]
  v_lshlrev_b32 v72, 16, v56
  v_and_b32 v73, s50, v56
  v_mfma_f32_16x16x32_bf16 v[36:39], v[192:195], a[20:23], v[36:39]
  v_lshlrev_b32 v74, 16, v57
  v_and_b32 v75, s50, v57
  v_mfma_f32_16x16x32_bf16 v[40:43], v[192:195], a[24:27], v[40:43]
  v_fma_f32 v16, v152, v16, v72
  v_fma_f32 v17, v153, v17, v73
  v_mfma_f32_16x16x32_bf16 v[44:47], v[192:195], a[28:31], v[44:47]
  buffer_load_dwordx4 v[192:195], v7, s[24:27], s65 offen
  s_waitcnt vmcnt(24)
  v_mfma_f32_16x16x32_bf16 v[32:35], v[196:199], a[32:35], v[32:35]
  v_fma_f32 v18, v154, v18, v74
  v_fma_f32 v19, v155, v19, v75
  v_mfma_f32_16x16x32_bf16 v[36:39], v[196:199], a[36:39], v[36:39]
  v_cvt_pk_bf16_f32 v56, v16, v17
  v_cvt_pk_bf16_f32 v57, v18, v19
  v_mfma_f32_16x16x32_bf16 v[40:43], v[196:199], a[40:43], v[40:43]
  ds_write_b64 v8, v[56:57] offset:0
  v_lshlrev_b32 v76, 16, v58
  v_mfma_f32_16x16x32_bf16 v[44:47], v[196:199], a[44:47], v[44:47]
  buffer_load_dwordx4 v[196:199], v7, s[24:27], s66 offen
  v_and_b32 v77, s50, v58
  v_mfma_f32_16x16x32_bf16 v[32:35], v[200:203], a[48:51], v[32:35]
  v_lshlrev_b32 v78, 16, v59
  v_and_b32 v79, s50, v59
  v_mfma_f32_16x16x32_bf16 v[36:39], v[200:203], a[52:55], v[36:39]
  v_fma_f32 v20, v156, v20, v76
  v_fma_f32 v21, v157, v21, v77
  v_mfma_f32_16x16x32_bf16 v[40:43], v[200:203], a[56:59], v[40:43]
  v_fma_f32 v22, v158, v22, v78
  v_fma_f32 v23, v159, v23, v79
  v_mfma_f32_16x16x32_bf16 v[44:47], v[200:203], a[60:63], v[44:47]
  buffer_load_dwordx4 v[200:203], v7, s[24:27], s67 offen
  s_waitcnt vmcnt(24)
  v_mfma_f32_16x16x32_bf16 v[32:35], v[204:207], a[64:67], v[32:35]
  v_cvt_pk_bf16_f32 v58, v20, v21
  v_cvt_pk_bf16_f32 v59, v22, v23
  v_mfma_f32_16x16x32_bf16 v[36:39], v[204:207], a[68:71], v[36:39]
  ds_write_b64 v8, v[58:59] offset:27648
  v_lshlrev_b32 v72, 16, v60
  v_mfma_f32_16x16x32_bf16 v[40:43], v[204:207], a[72:75], v[40:43]
  v_and_b32 v73, s50, v60
  v_lshlrev_b32 v74, 16, v61
  v_mfma_f32_16x16x32_bf16 v[44:47], v[204:207], a[76:79], v[44:47]
  buffer_load_dwordx4 v[204:207], v7, s[24:27], s68 offen
  v_and_b32 v75, s50, v61
  v_mfma_f32_16x16x32_bf16 v[32:35], v[208:211], a[80:83], v[32:35]
  v_fma_f32 v24, v160, v24, v72
  v_fma_f32 v25, v161, v25, v73
  v_mfma_f32_16x16x32_bf16 v[36:39], v[208:211], a[84:87], v[36:39]
  v_fma_f32 v26, v162, v26, v74
  v_fma_f32 v27, v163, v27, v75
  v_mfma_f32_16x16x32_bf16 v[40:43], v[208:211], a[88:91], v[40:43]
  v_cvt_pk_bf16_f32 v60, v24, v25
  v_cvt_pk_bf16_f32 v61, v26, v27
  v_mfma_f32_16x16x32_bf16 v[44:47], v[208:211], a[92:95], v[44:47]
  buffer_load_dwordx4 v[208:211], v7, s[24:27], s69 offen
  s_waitcnt vmcnt(24)
  v_mfma_f32_16x16x32_bf16 v[32:35], v[212:215], a[96:99], v[32:35]
  ds_write_b64 v9, v[60:61] offset:0
  v_lshlrev_b32 v76, 16, v62
  v_mfma_f32_16x16x32_bf16 v[36:39], v[212:215], a[100:103], v[36:39]
  v_and_b32 v77, s50, v62
  v_lshlrev_b32 v78, 16, v63
  v_mfma_f32_16x16x32_bf16 v[40:43], v[212:215], a[104:107], v[40:43]
  v_and_b32 v79, s50, v63
  v_fma_f32 v28, v164, v28, v76
  v_mfma_f32_16x16x32_bf16 v[44:47], v[212:215], a[108:111], v[44:47]
  buffer_load_dwordx4 v[212:215], v7, s[24:27], s70 offen
  v_fma_f32 v29, v165, v29, v77
  v_mfma_f32_16x16x32_bf16 v[32:35], v[216:219], a[112:115], v[32:35]
  v_fma_f32 v30, v166, v30, v78
  v_fma_f32 v31, v167, v31, v79
  v_mfma_f32_16x16x32_bf16 v[36:39], v[216:219], a[116:119], v[36:39]
  v_cvt_pk_bf16_f32 v62, v28, v29
  v_cvt_pk_bf16_f32 v63, v30, v31
  v_mfma_f32_16x16x32_bf16 v[40:43], v[216:219], a[120:123], v[40:43]
  ds_write_b64 v9, v[62:63] offset:27648
  v_add_u32 v10, s90, v4
  v_mfma_f32_16x16x32_bf16 v[44:47], v[216:219], a[124:127], v[44:47]
  buffer_load_dwordx4 v[216:219], v7, s[24:27], s71 offen
  s_waitcnt vmcnt(24)
  v_mfma_f32_16x16x32_bf16 v[32:35], v[220:223], a[128:131], v[32:35]
  v_add_u32 v11, s90, v5
  ds_read_b64 v[64:65], v10 offset:13824
  v_mfma_f32_16x16x32_bf16 v[36:39], v[220:223], a[132:135], v[36:39]
  ds_read_b64 v[66:67], v10 offset:41472
  ds_read_b64 v[68:69], v11 offset:13824
  v_mfma_f32_16x16x32_bf16 v[40:43], v[220:223], a[136:139], v[40:43]
  ds_read_b64 v[70:71], v11 offset:41472
  v_mfma_f32_16x16x32_bf16 v[44:47], v[220:223], a[140:143], v[44:47]
  buffer_load_dwordx4 v[220:223], v7, s[24:27], s72 offen
  v_mfma_f32_16x16x32_bf16 v[32:35], v[224:227], a[144:147], v[32:35]
  v_mfma_f32_16x16x32_bf16 v[36:39], v[224:227], a[148:151], v[36:39]
  v_mfma_f32_16x16x32_bf16 v[40:43], v[224:227], a[152:155], v[40:43]
  v_mfma_f32_16x16x32_bf16 v[44:47], v[224:227], a[156:159], v[44:47]
  buffer_load_dwordx4 v[224:227], v7, s[24:27], s73 offen
  s_waitcnt vmcnt(24)
  v_mfma_f32_16x16x32_bf16 v[32:35], v[228:231], a[160:163], v[32:35]
  v_mfma_f32_16x16x32_bf16 v[36:39], v[228:231], a[164:167], v[36:39]
  v_mfma_f32_16x16x32_bf16 v[40:43], v[228:231], a[168:171], v[40:43]
  v_mfma_f32_16x16x32_bf16 v[44:47], v[228:231], a[172:175], v[44:47]
  buffer_load_dwordx4 v[228:231], v7, s[24:27], s74 offen
  v_mfma_f32_16x16x32_bf16 v[32:35], v[232:235], a[176:179], v[32:35]
  v_mfma_f32_16x16x32_bf16 v[36:39], v[232:235], a[180:183], v[36:39]
  v_mfma_f32_16x16x32_bf16 v[40:43], v[232:235], a[184:187], v[40:43]
  v_mfma_f32_16x16x32_bf16 v[44:47], v[232:235], a[188:191], v[44:47]
  buffer_load_dwordx4 v[232:235], v7, s[24:27], s75 offen
  s_waitcnt vmcnt(25)
  v_mfma_f32_16x16x32_bf16 v[32:35], v[236:239], a[192:195], v[32:35]
  v_mfma_f32_16x16x32_bf16 v[36:39], v[236:239], a[196:199], v[36:39]
  v_mfma_f32_16x16x32_bf16 v[40:43], v[236:239], a[200:203], v[40:43]
  v_mfma_f32_16x16x32_bf16 v[44:47], v[236:239], a[204:207], v[44:47]
  buffer_load_dwordx4 v[236:239], v7, s[24:27], s76 offen
  s_nop 7
  s_nop 0
  s_waitcnt lgkmcnt(0)
  v_lshlrev_b32 v72, 16, v64
  v_and_b32 v73, s50, v64
  v_lshlrev_b32 v74, 16, v65
  v_and_b32 v75, s50, v65
  v_fma_f32 v32, v168, v32, v72
  v_fma_f32 v33, v169, v33, v73
  v_fma_f32 v34, v170, v34, v74
  v_fma_f32 v35, v171, v35, v75
  v_cvt_pk_bf16_f32 v64, v32, v33
  v_cvt_pk_bf16_f32 v65, v34, v35
  ds_write_b64 v10, v[64:65] offset:0
  v_lshlrev_b32 v76, 16, v66
  v_and_b32 v77, s50, v66
  v_lshlrev_b32 v78, 16, v67
  v_and_b32 v79, s50, v67
  v_fma_f32 v36, v172, v36, v76
  v_fma_f32 v37, v173, v37, v77
  v_fma_f32 v38, v174, v38, v78
  v_fma_f32 v39, v175, v39, v79
  v_cvt_pk_bf16_f32 v66, v36, v37
  v_cvt_pk_bf16_f32 v67, v38, v39
  ds_write_b64 v10, v[66:67] offset:27648
  v_lshlrev_b32 v72, 16, v68
  v_and_b32 v73, s50, v68
  v_lshlrev_b32 v74, 16, v69
  v_and_b32 v75, s50, v69
  v_fma_f32 v40, v176, v40, v72
  v_fma_f32 v41, v177, v41, v73
  v_fma_f32 v42, v178, v42, v74
  v_fma_f32 v43, v179, v43, v75
  v_cvt_pk_bf16_f32 v68, v40, v41
  v_cvt_pk_bf16_f32 v69, v42, v43
  ds_write_b64 v11, v[68:69] offset:0
  v_lshlrev_b32 v76, 16, v70
  v_and_b32 v77, s50, v70
  v_lshlrev_b32 v78, 16, v71
  v_and_b32 v79, s50, v71
  v_fma_f32 v44, v180, v44, v76
  v_fma_f32 v45, v181, v45, v77
  v_fma_f32 v46, v182, v46, v78
  v_fma_f32 v47, v183, v47, v79
  v_cvt_pk_bf16_f32 v70, v44, v45
  v_cvt_pk_bf16_f32 v71, v46, v47
  ds_write_b64 v11, v[70:71] offset:27648
  s_waitcnt lgkmcnt(0)
  s_barrier
  v_add_u32 v6, 3328, v6
  s_sub_u32 s35, s35, 1
  s_cmp_lg_u32 s35, 0
  s_cbranch_scc1 L_loop
  s_mov_b32 exec_hi, 0x000fffff
  ds_read_b128 a[0:3], v12
  ds_read_b128 a[4:7], v12 offset:864
  ds_read_b128 a[8:11], v12 offset:1728
  ds_read_b128 a[12:15], v12 offset:2592
  ds_read_b128 a[16:19], v12 offset:3456
  ds_read_b128 a[20:23], v12 offset:4320
  ds_read_b128 a[24:27], v12 offset:5184
  ds_read_b128 a[28:31], v12 offset:6048
  ds_read_b128 a[32:35], v12 offset:6912
  ds_read_b128 a[36:39], v12 offset:7776
  ds_read_b128 a[40:43], v12 offset:8640
  ds_read_b128 a[44:47], v12 offset:9504
  ds_read_b128 a[48:51], v12 offset:10368
  ds_read_b128 a[52:55], v12 offset:11232
  ds_read_b128 a[56:59], v12 offset:12096
  ds_read_b128 a[60:63], v12 offset:12960
  s_waitcnt lgkmcnt(12)
  buffer_store_dwordx4 a[0:3], v13, s[20:23], 0 offen
  buffer_store_dwordx4 a[4:7], v13, s[20:23], 0 offen offset:832
  buffer_store_dwordx4 a[8:11], v13, s[20:23], 0 offen offset:1664
  buffer_store_dwordx4 a[12:15], v13, s[20:23], 0 offen offset:2496
  s_waitcnt lgkmcnt(8)
  buffer_store_dwordx4 a[16:19], v13, s[20:23], s51 offen
  buffer_store_dwordx4 a[20:23], v13, s[20:23], s51 offen offset:832
  buffer_store_dwordx4 a[24:27], v13, s[20:23], s51 offen offset:1664
  buffer_store_dwordx4 a[28:31], v13, s[20:23], s51 offen offset:2496
  s_waitcnt lgkmcnt(4)
  buffer_store_dwordx4 a[32:35], v13, s[20:23], s52 offen
  buffer_store_dwordx4 a[36:39], v13, s[20:23], s52 offen offset:832
  buffer_store_dwordx4 a[40:43], v13, s[20:23], s52 offen offset:1664
  buffer_store_dwordx4 a[44:47], v13, s[20:23], s52 offen offset:2496
  s_waitcnt lgkmcnt(0)
  buffer_store_dwordx4 a[48:51], v13, s[20:23], s53 offen
  buffer_store_dwordx4 a[52:55], v13, s[20:23], s53 offen offset:832
  buffer_store_dwordx4 a[56:59], v13, s[20:23], s53 offen offset:1664
  buffer_store_dwordx4 a[60:63], v13, s[20:23], s53 offen offset:2496
L_main_end:
  s_endpgm
.section .rodata,"a"
.p2align 6
.amdhsa_kernel dcn_prep_kernel
  .amdhsa_next_free_vgpr 56
  .amdhsa_next_free_sgpr 32
  .amdhsa_accum_offset 56
  .amdhsa_group_segment_fixed_size 0
  .amdhsa_kernarg_size 48
  .amdhsa_user_sgpr_count 2
  .amdhsa_user_sgpr_kernarg_segment_ptr 1
  .amdhsa_system_sgpr_workgroup_id_x 1
.end_amdhsa_kernel
.p2align 6
.amdhsa_kernel standalone__cross_network_dcn__recsys_kernel
  .amdhsa_next_free_vgpr 512
  .amdhsa_next_free_sgpr 102
  .amdhsa_accum_offset 256
  .amdhsa_group_segment_fixed_size 0
  .amdhsa_kernarg_size 48
  .amdhsa_user_sgpr_count 2
  .amdhsa_user_sgpr_kernarg_segment_ptr 1
  .amdhsa_system_sgpr_workgroup_id_x 1
.end_amdhsa_kernel
```
